```python
import torch

def _softmax(x, axis=-1):
    return torch.softmax(x, dim=axis)
def _gelu(x):
    return torch.nn.functional.gelu(x, approximate="tanh")
def _silu(x):
    return torch.nn.functional.silu(x)
def _sigmoid(x):
    return torch.sigmoid(x)
def _layernorm(x, axis=-1, eps=1e-5):
    m = x.mean(dim=axis, keepdim=True)
    v = x.var(dim=axis, keepdim=True, unbiased=False)
    return (x - m) / torch.sqrt(v + eps)
def _scatter_add(tgt, idx, src, axis=0):
    return tgt.clone().index_add_(axis, idx, src)
def _segment_sum(src, seg, n):
    out = torch.zeros((n,) + src.shape[1:], dtype=src.dtype)
    return out.index_add_(0, seg, src)
def _pad(x, pw):
    flat = tuple(v for pair in reversed(pw) for v in pair)
    return torch.nn.functional.pad(x, flat)

kernel_name = 'gated_mix__grouped_kv_mqa__glu_gated_geglu__prompt'

def setup_inputs():

    _w = (lambda a: (lambda t: t.to(torch.bfloat16) if t.is_floating_point() else t)(torch.as_tensor(a)))
    def _A_setup():
        B, S, D, H = 1, 2048, 640, 32
        Dh = D // H
        return {
            "x": _w((lambda *s: torch.randn(*s, dtype=torch.bfloat16) * 0.05)(B, S, D)),
            "wq": _w((lambda *s: torch.randn(*s, dtype=torch.bfloat16) * 0.8)(D, H * Dh)),
            "wk": _w((lambda *s: torch.randn(*s, dtype=torch.bfloat16) * 0.8)(D, Dh)),
            "wv": _w((lambda *s: torch.randn(*s, dtype=torch.bfloat16) * 0.05)(D, Dh)),
            "wo": _w((lambda *s: torch.randn(*s, dtype=torch.bfloat16) * 0.05)(H * Dh, D)),
        }
    _A_in = _A_setup()

    def _B_setup():
        B, S, Dm, Df = 1, 2048, 640, 1536
        return {
            "x": _w((lambda *s: torch.randn(*s, dtype=torch.bfloat16) * 0.05)(B, S, Dm)),
            "w_gate": _w((lambda *s: torch.randn(*s, dtype=torch.bfloat16) * 0.8)(Dm, Df) * (Dm ** -0.5)),
            "w_up": _w((lambda *s: torch.randn(*s, dtype=torch.bfloat16) * 0.8)(Dm, Df) * (Dm ** -0.5)),
            "w_down": _w((lambda *s: torch.randn(*s, dtype=torch.bfloat16) * 0.8)(Df, Dm) * (Df ** -0.5)),
        }
    _B_in = _B_setup()

    return {
        "A_x": _A_in["x"],
        "A_wq": _A_in["wq"],
        "A_wk": _A_in["wk"],
        "A_wv": _A_in["wv"],
        "A_wo": _A_in["wo"],
        "B_x": _B_in["x"],
        "B_w_gate": _B_in["w_gate"],
        "B_w_up": _B_in["w_up"],
        "B_w_down": _B_in["w_down"],
        "gate_w": _w((lambda *s: torch.randn(*s, dtype=torch.bfloat16) * 0.05)(640) * 16.0),
    }

def reference(A_x, A_wq, A_wk, A_wv, A_wo, B_x, B_w_gate, B_w_up, B_w_down, gate_w):
    def _A_ref(x, wq, wk, wv, wo):
        B, S, D = x.shape
        H = 32
        Dh = D // H
        q = (lambda x, *d: x.permute(*d))((x @ wq).reshape(B, S, H, Dh), 0, 2, 1, 3)
        k = x @ wk
        v = x @ wv
        scores = torch.einsum("bhqd,bkd->bhqk", q, k) * (Dh ** -0.5)
        p = _softmax(scores, axis=-1)
        o = torch.einsum("bhqk,bkd->bhqd", p, v)
        return (lambda x, *d: x.permute(*d))(o, 0, 2, 1, 3).reshape(B, S, H * Dh) @ wo

    def _B_ref(x, w_gate, w_up, w_down):
        g = torch.einsum("bsd,df->bsf", x, w_gate)
        u = torch.einsum("bsd,df->bsf", x, w_up)
        h = _gelu(g) * u
        return torch.einsum("bsf,fd->bsd", h, w_down)

    x = A_x
    g = _sigmoid((x * gate_w).sum(-1, keepdims=True))
    a = _A_ref(x, A_wq, A_wk, A_wv, A_wo)
    b = _B_ref(x, B_w_gate, B_w_up, B_w_down)
    return g * a + (1 - g) * b
```

```asm
; @launch grid=(256,1,1) block=(512,1,1) lds=163840
.amdgcn_target "amdgcn-amd-amdhsa--gfx950"
.text
.p2align 8
.globl gated_mix__grouped_kv_mqa__glu_gated_geglu__prompt_kernel
.type gated_mix__grouped_kv_mqa__glu_gated_geglu__prompt_kernel,@function
gated_mix__grouped_kv_mqa__glu_gated_geglu__prompt_kernel:
	s_cmp_ge_u32 s2, 256
	s_cbranch_scc1 L_exit
	s_load_dwordx16 s[32:47], s[0:1], 0
	s_load_dwordx8 s[48:55], s[0:1], 64
	s_load_dwordx2 s[56:57], s[0:1], 96
	s_getpc_b64 s[98:99]
L_pc:
	v_lshrrev_b32 v10, 6, v0
	v_and_b32 v11, 63, v0
	v_readfirstlane_b32 s16, v10
	s_and_b32 s3, s2, 1
	s_lshl_b32 s3, s3, 3
	s_bfe_u32 s66, s2, 0x30003
	s_add_u32 s3, s3, s66
	s_bfe_u32 s17, s2, 0x20001
	s_lshl_b32 s17, s17, 2
	s_lshr_b32 s67, s2, 6
	s_add_u32 s17, s17, s67
	s_lshr_b32 s58, s66, 2
	s_add_u32 s58, s58, s66
	s_mul_i32 s67, s67, 5
	s_add_u32 s67, s67, 1
	s_lshr_b32 s67, s67, 1
	s_add_u32 s58, s58, s67
	s_and_b32 s67, s2, 1
	s_mul_i32 s67, s67, 2
	s_add_u32 s58, s58, s67
	s_sub_u32 s67, s58, 10
	s_cselect_b32 s58, s58, s67
	s_and_b32 s18, s16, 1
	s_lshr_b32 s19, s16, 1
	v_lshlrev_b32 v14, 4, v11
	v_lshrrev_b32 v56, 3, v11
	s_lshl_b32 s66, s16, 4
	v_add_u32 v56, s66, v56
	v_mul_u32_u24 v56, 1280, v56
	v_and_b32 v57, 7, v11
	v_lshrrev_b32 v58, 4, v11
	v_xor_b32 v57, v57, v58
	v_lshl_add_u32 v7, v57, 4, v56
	v_xor_b32 v57, 4, v57
	v_lshl_add_u32 v8, v57, 4, v56
	v_add_u32 v8, 10240, v8
	s_and_b32 s66, s16, 3
	s_mul_i32 s67, s66, 49152
	v_add_u32 v56, 0, v11
	v_mul_u32_u24 v57, 43691, v56
	v_lshrrev_b32 v57, 19, v57
	v_mul_u32_u24 v57, 2880, v57
	v_lshl_add_u32 v57, v56, 4, v57
	v_add_u32 v9, s67, v57
	v_add_u32 v56, 64, v11
	v_mul_u32_u24 v57, 43691, v56
	v_lshrrev_b32 v57, 19, v57
	v_mul_u32_u24 v57, 2880, v57
	v_lshl_add_u32 v57, v56, 4, v57
	v_add_u32 v10, s67, v57
	v_add_u32 v56, 128, v11
	v_mul_u32_u24 v57, 43691, v56
	v_lshrrev_b32 v57, 19, v57
	v_mul_u32_u24 v57, 2880, v57
	v_lshl_add_u32 v57, v56, 4, v57
	v_add_u32 v12, s67, v57
	s_lshl_b32 s63, s16, 11
	s_mul_i32 s64, s66, 3072
	s_cmp_ge_u32 s16, 4
	s_cselect_b32 s67, 12320, 0
	s_add_u32 s64, s64, s67
	s_add_u32 s64, s64, 49152
	s_cmp_ge_u32 s16, 6
	s_cselect_b64 vcc, -1, 0
	s_cbranch_scc1 L_p6c
	s_mov_b32 s62, 81920
	s_lshl_b32 s65, s16, 10
	s_add_u32 s65, s65, 73760
	s_lshl_b32 s66, s16, 6
	v_add_u32 v56, s66, v11
	v_mul_u32_u24 v57, 13108, v56
	v_lshrrev_b32 v57, 16, v57
	v_mul_u32_u24 v57, 1200, v57
	v_lshl_add_u32 v13, v56, 4, v57
	s_cmp_eq_u32 s16, 5
	s_cselect_b32 s66, 0x40000000, 0
	v_or_b32 v13, s66, v13
	s_branch L_p6d
L_p6c:
	s_movk_i32 s62, 128
	s_lshl_b32 s65, s18, 8
	s_add_u32 s65, s65, 79904
	s_lshl_b32 s66, s18, 6
	v_and_b32 v56, 62, v11
	v_add_u32 v13, s66, v56
L_p6d:
	s_lshl_b32 s59, s58, 7
	s_mul_i32 s60, s58, 196608
	s_mul_i32 s61, s58, s62
	s_mul_i32 s66, s3, 163840
	s_mul_i32 s67, s17, 192
	s_sub_u32 s10, 1966080, s67
	s_mul_i32 s68, s17, 80
	s_sub_u32 s14, 819200, s68
	s_mov_b32 s6, 163840
	s_mov_b32 s7, 0x00020000
	s_mov_b32 s11, 0x00020000
	s_mov_b32 s15, 0x00020000
	s_movk_i32 s22, 25600
	s_mov_b32 s23, 0x00020000
	v_and_b32 v56, 15, v11
	v_xor_b32 v56, v56, v58
	v_mul_u32_u24 v57, 1280, v58
	v_xor_b32 v59, 0, v56
	v_lshl_add_u32 v32, v59, 4, v57
	v_xor_b32 v59, 4, v56
	v_lshl_add_u32 v33, v59, 4, v57
	v_add_u32 v33, 5120, v33
	v_xor_b32 v59, 8, v56
	v_lshl_add_u32 v34, v59, 4, v57
	v_add_u32 v34, 10240, v34
	v_xor_b32 v59, 12, v56
	v_lshl_add_u32 v35, v59, 4, v57
	v_add_u32 v35, 15360, v35
	s_mul_i32 s70, s16, 5120
	s_lshr_b32 s71, s17, 1
	s_mul_i32 s71, s71, 20480
	s_lshl_b32 s100, s16, 8
	s_add_u32 s71, s71, s100
	s_lshl_b32 s100, s16, 12
	s_add_u32 s100, s100, 143040
	s_waitcnt lgkmcnt(0)
	s_cmp_ge_u32 s16, 4
	s_cselect_b32 s8, s46, s44
	s_cselect_b32 s9, s47, s45
	s_add_u32 s8, s8, s67
	s_addc_u32 s9, s9, 0
	buffer_load_dword v46, off, s[8:11], s60
	s_add_u32 s12, s34, s68
	s_addc_u32 s13, s35, 0
	s_cmp_ge_u32 s16, 6
	s_cselect_b32 s12, s50, s12
	s_cselect_b32 s13, s51, s13
	s_cselect_b32 s14, 1280, s14
	buffer_load_dword v47, off, s[12:15], s61
	s_add_u32 s4, s32, s66
	s_addc_u32 s5, s33, 0
	s_bitcmp1_b32 s17, 0
	s_cselect_b32 s20, s38, s36
	s_cselect_b32 s21, s39, s37
	s_add_u32 s24, s56, 0
	s_addc_u32 s25, s57, 0
	s_mov_b32 s26, 16777216
	s_mov_b32 s27, 0x00020000
	s_lshr_b32 s66, s2, 3
	s_lshl_b32 s66, s66, 10
	v_lshl_add_u32 v1, v0, 1, s66
	v_min_u32 v1, L_last-L_pc, v1
	global_load_ubyte v46, v1, s[98:99]
	s_cmp_ge_u32 s16, 5
	s_cbranch_scc1 LN_3
	s_add_u32 m0, s100, 0
	s_nop 0
	buffer_load_dwordx4 v32, s[4:7], s71 offen lds
	s_add_u32 m0, s70, 111744
	s_nop 0
	buffer_load_dwordx4 v14, s[20:23], s70 offen offset:0 lds
	s_add_u32 m0, s100, 1024
	s_nop 0
	buffer_load_dwordx4 v33, s[4:7], s71 offen lds
	s_add_u32 m0, s70, 112768
	s_add_u32 s67, s70, 1024
	buffer_load_dwordx4 v14, s[20:23], s67 offen lds
	s_add_u32 m0, s100, 2048
	s_nop 0
	buffer_load_dwordx4 v34, s[4:7], s71 offen lds
	s_add_u32 m0, s70, 113792
	s_add_u32 s67, s70, 2048
	buffer_load_dwordx4 v14, s[20:23], s67 offen lds
	s_add_u32 m0, s100, 3072
	s_nop 0
	buffer_load_dwordx4 v35, s[4:7], s71 offen lds
	s_add_u32 m0, s70, 114816
	s_add_u32 s67, s70, 3072
	buffer_load_dwordx4 v14, s[20:23], s67 offen lds
	s_add_u32 m0, s70, 115840
	s_add_u32 s67, s70, 4096
	buffer_load_dwordx4 v14, s[20:23], s67 offen lds
	s_branch LN_4
LN_3:
	s_mov_b32 s66, 0x14000
	buffer_load_dword v45, off, s[24:27], s66
LN_4:
	s_add_u32 m0, s63, 0
	s_nop 0
	buffer_load_dwordx4 v7, s[4:7], s59 offen lds
	s_add_u32 m0, s63, 1024
	s_nop 0
	buffer_load_dwordx4 v8, s[4:7], s59 offen lds
	s_add_u32 m0, s64, 0
	s_nop 0
	buffer_load_dwordx4 v9, s[8:11], s60 offen lds
	s_add_u32 m0, s64, 1024
	s_nop 0
	buffer_load_dwordx4 v10, s[8:11], s60 offen lds
	s_add_u32 m0, s64, 2048
	s_nop 0
	buffer_load_dwordx4 v12, s[8:11], s60 offen lds
	s_add_u32 m0, s65, 0
	s_cbranch_vccnz U_1
	buffer_load_dwordx4 v13, s[12:15], s61 offen lds
	s_branch U_2
U_1:
	buffer_load_ushort v13, s[12:15], s61 offen lds
U_2:
L_fill:
	v_bfe_u32 v56, v11, 2, 2
	v_lshl_add_u32 v56, v58, 3, v56
	v_mul_u32_u24 v56, 40, v56
	v_and_b32 v57, 3, v11
	v_lshl_add_u32 v56, v57, 3, v56
	s_add_u32 s66, s70, 111744
	v_add_u32 v40, s66, v56
	v_and_b32 v56, 15, v11
	v_xor_b32 v57, v56, v58
	v_lshlrev_b32 v56, 8, v56
	v_add_u32 v56, s100, v56
	v_xor_b32 v59, 0, v57
	v_lshl_add_u32 v41, v59, 4, v56
	v_xor_b32 v59, 4, v57
	v_lshl_add_u32 v42, v59, 4, v56
	v_xor_b32 v59, 8, v57
	v_lshl_add_u32 v43, v59, 4, v56
	v_xor_b32 v59, 12, v57
	v_lshl_add_u32 v44, v59, 4, v56
	v_add_u32 v39, s100, v14
	v_and_b32 v60, 31, v11
	v_lshrrev_b32 v61, 5, v11
	v_bfe_u32 v56, v11, 1, 3
	v_xor_b32 v56, v56, v61
	s_lshl_b32 s66, s18, 13
	v_lshlrev_b32 v57, 7, v60
	v_add_u32 v57, s66, v57
	v_xor_b32 v59, 0, v56
	v_lshl_add_u32 v1, v59, 4, v57
	v_xor_b32 v59, 2, v56
	v_lshl_add_u32 v2, v59, 4, v57
	v_xor_b32 v59, 4, v56
	v_lshl_add_u32 v3, v59, 4, v57
	v_xor_b32 v59, 6, v56
	v_lshl_add_u32 v4, v59, 4, v57
	v_bfe_u32 v56, v11, 2, 2
	v_lshl_add_u32 v62, v61, 3, v56
	v_and_b32 v56, 1, v11
	v_bfe_u32 v57, v11, 1, 1
	v_bfe_u32 v59, v11, 4, 1
	s_mul_i32 s66, s19, 48
	s_add_u32 s66, s66, 49152
	v_mul_u32_u24 v5, 192, v62
	v_mul_u32_u24 v63, 12320, v59
	v_add3_u32 v5, v5, v63, s66
	v_lshl_add_u32 v5, v56, 4, v5
	v_lshl_add_u32 v5, v57, 3, v5
	v_add_u32 v6, 62592, v5
	v_cmp_eq_u32 s[68:69], 1, v59
	v_mul_u32_u24 v63, 12320, v57
	v_lshl_add_u32 v63, v56, 3, v63
	s_add_u32 s66, s66, 32
	v_add_u32 v63, s66, v63
	s_cmp_eq_u32 s19, 2
	s_cbranch_scc1 L_tb2
	s_mul_i32 s66, s19, 40
	s_cmp_eq_u32 s19, 3
	s_cselect_b32 s66, 5120, s66
	s_cselect_b32 s67, 0, 80
	s_add_u32 s66, s66, 73760
	v_lshlrev_b32 v16, 4, v56
	v_lshl_add_u32 v16, v57, 3, v16
	v_add_u32 v16, s66, v16
	v_mov_b32 v17, s67
	s_branch L_tb3
L_tb2:
	v_cmp_eq_u32 s[66:67], 1, v57
	v_mul_u32_u24 v16, 40, v56
	v_add_u32 v16, 73792, v16
	v_mov_b32 v17, 79904
	v_cndmask_b32 v16, v16, v17, s[66:67]
	v_mov_b32 v17, 80
	v_cndmask_b32 v17, v17, 8, s[66:67]
L_tb3:
	v_cndmask_b32 v63, v63, v16, s[68:69]
	v_mov_b32 v16, 192
	v_cndmask_b32 v59, v16, v17, s[68:69]
	v_mad_u32_u24 v63, v62, v59, v63
	v_mad_u32_u24 v48, v59, 0, v63
	v_mad_u32_u24 v49, v59, 4, v63
	v_mad_u32_u24 v50, v59, 16, v63
	v_mad_u32_u24 v51, v59, 20, v63
	v_mad_u32_u24 v52, v59, 32, v63
	v_mad_u32_u24 v53, v59, 36, v63
	v_mad_u32_u24 v54, v59, 48, v63
	v_mad_u32_u24 v55, v59, 52, v63
	s_mov_b32 s72, 0xfffff
	s_mov_b32 s73, 0xfffff
	s_bfe_u32 s42, s2, 0x20003
	s_lshl_b32 s42, s42, 2
	s_bfe_u32 s66, s2, 0x10006
	s_lshl4_add_u32 s42, s66, s42
	v_and_b32 v56, 31, v11
	v_cmp_eq_u32 s[66:67], 20, v56
	v_mov_b32 v57, 0x3f803f80
	s_nop 0
	v_cndmask_b32 v137, 0, v57, s[66:67]
	v_mov_b32 v152, 0x3f803f80
	v_mov_b32 v153, 0x3f80
	v_mov_b32 v156, v137
	v_mov_b32 v157, v137
	v_mov_b32 v158, v137
	v_mov_b32 v159, v137
	v_mov_b32 v160, v137
	v_mov_b32 v161, v137
	v_mov_b32 v162, v137
	v_mov_b32 v163, v137
	v_mov_b32 v154, 0x3f803f80
	v_mov_b32 v155, 0x3f80
	v_mov_b32 v164, v137
	v_mov_b32 v165, v137
	v_mov_b32 v166, v137
	v_mov_b32 v167, v137
	v_mov_b32 v168, v137
	v_mov_b32 v169, v137
	v_mov_b32 v170, v137
	v_mov_b32 v171, v137
	v_mov_b32 v180, 0x3f803f80
	v_mov_b32 v181, 0x3f80
	v_mov_b32 v184, v137
	v_mov_b32 v185, v137
	v_mov_b32 v186, v137
	v_mov_b32 v187, v137
	v_mov_b32 v188, v137
	v_mov_b32 v189, v137
	v_mov_b32 v190, v137
	v_mov_b32 v191, v137
	v_mov_b32 v182, 0x3f803f80
	v_mov_b32 v183, 0x3f80
	v_mov_b32 v192, v137
	v_mov_b32 v193, v137
	v_mov_b32 v194, v137
	v_mov_b32 v195, v137
	v_mov_b32 v196, v137
	v_mov_b32 v197, v137
	v_mov_b32 v198, v137
	v_mov_b32 v199, v137
	v_mov_b32 v208, 0x3f803f80
	v_mov_b32 v209, 0x3f80
	v_mov_b32 v212, v137
	v_mov_b32 v213, v137
	v_mov_b32 v214, v137
	v_mov_b32 v215, v137
	v_mov_b32 v216, v137
	v_mov_b32 v217, v137
	v_mov_b32 v218, v137
	v_mov_b32 v219, v137
	v_mov_b32 v210, 0x3f803f80
	v_mov_b32 v211, 0x3f80
	v_mov_b32 v220, v137
	v_mov_b32 v221, v137
	v_mov_b32 v222, v137
	v_mov_b32 v223, v137
	v_mov_b32 v224, v137
	v_mov_b32 v225, v137
	v_mov_b32 v226, v137
	v_mov_b32 v227, v137
	v_mov_b32 v236, 0x3f803f80
	v_mov_b32 v237, 0x3f80
	v_mov_b32 v240, v137
	v_mov_b32 v241, v137
	v_mov_b32 v242, v137
	v_mov_b32 v243, v137
	v_mov_b32 v244, v137
	v_mov_b32 v245, v137
	v_mov_b32 v246, v137
	v_mov_b32 v247, v137
	v_mov_b32 v238, 0x3f803f80
	v_mov_b32 v239, 0x3f80
	v_mov_b32 v248, v137
	v_mov_b32 v249, v137
	v_mov_b32 v250, v137
	v_mov_b32 v251, v137
	v_mov_b32 v252, v137
	v_mov_b32 v253, v137
	v_mov_b32 v254, v137
	v_mov_b32 v255, v137
	v_bfe_u32 v56, v11, 3, 2
	v_mul_u32_u24 v133, 640, v56
	v_lshrrev_b32 v56, 5, v11
	v_lshl_add_u32 v133, v56, 7, v133
	v_mul_u32_u24 v134, 640, v56
	v_bfe_u32 v56, v11, 2, 1
	v_lshl_add_u32 v133, v56, 6, v133
	v_and_b32 v56, 3, v11
	v_lshl_add_u32 v133, v56, 4, v133
	v_lshl_add_u32 v134, v56, 4, v134
	v_and_b32 v56, 28, v11
	v_mov_b32 v57, 0x43120
	v_lshrrev_b32 v56, v56, v57
	v_and_b32 v56, 7, v56
	v_lshl_add_u32 v134, v56, 6, v134
	v_bfe_u32 v56, v11, 4, 1
	v_mul_u32_u24 v56, 49152, v56
	v_and_b32 v57, 15, v11
	v_lshl_add_u32 v56, v57, 4, v56
	v_lshrrev_b32 v57, 5, v11
	v_lshl_add_u32 v135, v57, 8, v56
	v_mul_u32_u24 v57, 98304, v57
	v_add_u32 v136, v56, v57
	v_add_u32 v56, 0, v11
	v_mul_u32_u24 v57, 6554, v56
	v_lshrrev_b32 v57, 16, v57
	v_mul_u32_u24 v58, 10, v57
	v_sub_u32 v56, v56, v58
	v_and_b32 v58, 12, v57
	v_lshlrev_b32 v58, 1, v58
	v_and_b32 v59, 3, v57
	v_or_b32 v58, v58, v59
	v_lshrrev_b32 v59, 4, v57
	v_lshl_add_u32 v58, v59, 2, v58
	v_mul_u32_u24 v58, 1280, v58
	v_lshl_add_u32 v140, v56, 4, v58
	v_add_u32 v56, 64, v11
	v_mul_u32_u24 v57, 6554, v56
	v_lshrrev_b32 v57, 16, v57
	v_mul_u32_u24 v58, 10, v57
	v_sub_u32 v56, v56, v58
	v_and_b32 v58, 12, v57
	v_lshlrev_b32 v58, 1, v58
	v_and_b32 v59, 3, v57
	v_or_b32 v58, v58, v59
	v_lshrrev_b32 v59, 4, v57
	v_lshl_add_u32 v58, v59, 2, v58
	v_mul_u32_u24 v58, 1280, v58
	v_lshl_add_u32 v141, v56, 4, v58
	v_add_u32 v56, 128, v11
	v_mul_u32_u24 v57, 6554, v56
	v_lshrrev_b32 v57, 16, v57
	v_mul_u32_u24 v58, 10, v57
	v_sub_u32 v56, v56, v58
	v_and_b32 v58, 12, v57
	v_lshlrev_b32 v58, 1, v58
	v_and_b32 v59, 3, v57
	v_or_b32 v58, v58, v59
	v_lshrrev_b32 v59, 4, v57
	v_lshl_add_u32 v58, v59, 2, v58
	v_mul_u32_u24 v58, 1280, v58
	v_lshl_add_u32 v142, v56, 4, v58
	v_add_u32 v56, 192, v11
	v_mul_u32_u24 v57, 6554, v56
	v_lshrrev_b32 v57, 16, v57
	v_mul_u32_u24 v58, 10, v57
	v_sub_u32 v56, v56, v58
	v_and_b32 v58, 12, v57
	v_lshlrev_b32 v58, 1, v58
	v_and_b32 v59, 3, v57
	v_or_b32 v58, v58, v59
	v_lshrrev_b32 v59, 4, v57
	v_lshl_add_u32 v58, v59, 2, v58
	v_mul_u32_u24 v58, 1280, v58
	v_lshl_add_u32 v143, v56, 4, v58
	v_add_u32 v56, 256, v11
	v_mul_u32_u24 v57, 6554, v56
	v_lshrrev_b32 v57, 16, v57
	v_mul_u32_u24 v58, 10, v57
	v_sub_u32 v56, v56, v58
	v_and_b32 v58, 12, v57
	v_lshlrev_b32 v58, 1, v58
	v_and_b32 v59, 3, v57
	v_or_b32 v58, v58, v59
	v_lshrrev_b32 v59, 4, v57
	v_lshl_add_u32 v58, v59, 2, v58
	v_mul_u32_u24 v58, 1280, v58
	v_lshl_add_u32 v15, v56, 4, v58
	s_mov_b32 s28, s54
	s_mov_b32 s29, s55
	s_movk_i32 s30, 256
	s_mov_b32 s31, 0x00020000
	v_lshlrev_b32 v138, 2, v11
	s_lshr_b32 s66, s2, 3
	s_add_u32 s66, s66, 0
	s_and_b32 s66, s66, 3
	s_lshl_b32 s67, s16, 2
	s_add_u32 s66, s66, s67
	s_mul_i32 s74, s66, 2560
	s_lshr_b32 s66, s2, 3
	s_add_u32 s66, s66, 1
	s_and_b32 s66, s66, 3
	s_lshl_b32 s67, s16, 2
	s_add_u32 s66, s66, s67
	s_mul_i32 s75, s66, 2560
	s_lshr_b32 s66, s2, 3
	s_add_u32 s66, s66, 2
	s_and_b32 s66, s66, 3
	s_lshl_b32 s67, s16, 2
	s_add_u32 s66, s66, s67
	s_mul_i32 s76, s66, 2560
	s_lshr_b32 s66, s2, 3
	s_add_u32 s66, s66, 3
	s_and_b32 s66, s66, 3
	s_lshl_b32 s67, s16, 2
	s_add_u32 s66, s66, s67
	s_mul_i32 s77, s66, 2560
	v_add_u32 v134, 131072, v134
	v_mov_b32 v128, 0xc0135761
	v_mov_b32 v129, 0xc0135761
	v_mov_b32 v130, 0xbdd2d3e8
	v_mov_b32 v131, 0xbdd2d3e8
	v_mov_b32 v62, 1.0
	v_mov_b32 v63, 1.0
	s_lshl_b32 s66, s3, 1
	s_add_u32 s66, s66, s18
	s_mul_i32 s66, s66, 196608
	s_lshl_b32 s67, s17, 2
	s_add_u32 s67, s67, s19
	s_mul_i32 s67, s67, 768
	s_add_u32 s66, s66, s67
	s_add_u32 s78, s66, 1048576
	s_add_u32 s79, s78, 98304
	v_lshrrev_b32 v56, 2, v11
	v_mul_u32_u24 v56, 160, v56
	v_and_b32 v57, 3, v11
	v_mul_u32_u24 v57, 40, v57
	s_lshr_b32 s66, s19, 1
	s_mul_i32 s66, s66, 10240
	v_add3_u32 v0, v56, v57, s66
	v_mov_b32 v60, 1
	v_mov_b32 v61, 0
	s_and_b32 s101, s2, 63
	s_lshl_b32 s101, s101, 2
L_both:
	s_cmp_lt_u32 s16, 5
	s_cbranch_scc1 L_p0
L_p0ret:
	s_lshr_b32 s59, 0x55555555, s42
	s_and_b32 s59, s59, 15
	s_add_u32 s59, s59, s58
	s_sub_u32 s60, s59, 10
	s_cselect_b32 s59, s59, s60
	s_mul_i32 s60, s59, 196608
	s_mul_i32 s61, s59, s62
	s_lshl_b32 s59, s59, 7
	s_add_u32 m0, s63, 16384
	s_nop 0
	buffer_load_dwordx4 v7, s[4:7], s59 offen lds
	s_add_u32 m0, s63, 17408
	s_nop 0
	buffer_load_dwordx4 v8, s[4:7], s59 offen lds
	s_add_u32 m0, s64, 31296
	s_nop 0
	buffer_load_dwordx4 v9, s[8:11], s60 offen lds
	s_waitcnt vmcnt(3)
	s_barrier
	ds_read_b128 v[16:19], v1 offset:0
	ds_read_b128 v[20:23], v1 offset:4096
	ds_read_b64_tr_b16 v[24:25], v5 offset:0
	ds_read_b64_tr_b16 v[26:27], v5 offset:768
	ds_read_b64_tr_b16 v[28:29], v48 offset:0
	ds_read_b64_tr_b16 v[30:31], v49 offset:0
	ds_read_b128 v[32:35], v2 offset:0
	ds_read_b128 v[36:39], v2 offset:4096
	ds_read_b64_tr_b16 v[40:41], v5 offset:3072
	ds_read_b64_tr_b16 v[42:43], v5 offset:3840
	ds_read_b64_tr_b16 v[44:45], v50 offset:0
	ds_read_b64_tr_b16 v[46:47], v51 offset:0
	s_waitcnt lgkmcnt(6)
	v_mfma_f32_32x32x16_bf16 v[64:79], v[24:27], v[16:19], 0
	s_add_u32 m0, s64, 32320
	s_nop 0
	buffer_load_dwordx4 v10, s[8:11], s60 offen lds
	v_mfma_f32_32x32x16_bf16 v[80:95], v[24:27], v[20:23], 0
	s_add_u32 m0, s64, 33344
	s_nop 0
	buffer_load_dwordx4 v12, s[8:11], s60 offen lds
	v_mfma_f32_32x32x16_bf16 v[96:111], v[28:31], v[16:19], 0
	s_add_u32 m0, s65, 31296
	s_cbranch_vccnz U_5
	buffer_load_dwordx4 v13, s[12:15], s61 offen lds
	s_branch U_6
U_5:
	buffer_load_ushort v13, s[12:15], s61 offen lds
U_6:
	v_mfma_f32_32x32x16_bf16 v[112:127], v[28:31], v[20:23], 0
	s_lshr_b32 s59, 0x21223313, s42
	s_and_b32 s59, s59, 15
	s_add_u32 s59, s59, s58
	s_sub_u32 s60, s59, 10
	s_cselect_b32 s59, s59, s60
	s_mul_i32 s60, s59, 196608
	s_mul_i32 s61, s59, s62
	s_lshl_b32 s59, s59, 7
	s_add_u32 m0, s64, 62592
	s_nop 0
	buffer_load_dwordx4 v9, s[8:11], s60 offen lds
	ds_read_b128 v[16:19], v3 offset:0
	ds_read_b128 v[20:23], v3 offset:4096
	ds_read_b64_tr_b16 v[24:25], v5 offset:6144
	ds_read_b64_tr_b16 v[26:27], v5 offset:6912
	ds_read_b64_tr_b16 v[28:29], v52 offset:0
	ds_read_b64_tr_b16 v[30:31], v53 offset:0
	s_waitcnt lgkmcnt(6)
	v_mfma_f32_32x32x16_bf16 v[64:79], v[40:43], v[32:35], v[64:79]
	s_add_u32 m0, s64, 63616
	s_nop 0
	buffer_load_dwordx4 v10, s[8:11], s60 offen lds
	v_mfma_f32_32x32x16_bf16 v[80:95], v[40:43], v[36:39], v[80:95]
	s_add_u32 m0, s64, 64640
	s_nop 0
	buffer_load_dwordx4 v12, s[8:11], s60 offen lds
	v_mfma_f32_32x32x16_bf16 v[96:111], v[44:47], v[32:35], v[96:111]
	s_add_u32 m0, s65, 62592
	s_cbranch_vccnz U_7
	buffer_load_dwordx4 v13, s[12:15], s61 offen lds
	s_branch U_8
U_7:
	buffer_load_ushort v13, s[12:15], s61 offen lds
U_8:
	v_mfma_f32_32x32x16_bf16 v[112:127], v[44:47], v[36:39], v[112:127]
	s_add_u32 m0, s63, 32768
	s_nop 0
	buffer_load_dwordx4 v7, s[4:7], s59 offen lds
	ds_read_b128 v[32:35], v4 offset:0
	ds_read_b128 v[36:39], v4 offset:4096
	ds_read_b64_tr_b16 v[40:41], v5 offset:9216
	ds_read_b64_tr_b16 v[42:43], v5 offset:9984
	ds_read_b64_tr_b16 v[44:45], v54 offset:0
	ds_read_b64_tr_b16 v[46:47], v55 offset:0
	s_waitcnt lgkmcnt(6)
	v_mfma_f32_32x32x16_bf16 v[64:79], v[24:27], v[16:19], v[64:79]
	s_add_u32 m0, s63, 33792
	s_nop 0
	buffer_load_dwordx4 v8, s[4:7], s59 offen lds
	v_mfma_f32_32x32x16_bf16 v[80:95], v[24:27], v[20:23], v[80:95]
	v_mfma_f32_32x32x16_bf16 v[96:111], v[28:31], v[16:19], v[96:111]
	v_mfma_f32_32x32x16_bf16 v[112:127], v[28:31], v[20:23], v[112:127]
	s_waitcnt lgkmcnt(0)
	s_cmp_eq_u32 s16, 0
	s_cbranch_scc1 L_red
	s_waitcnt vmcnt(6)
L_redret:
	s_barrier
	ds_read_b128 v[16:19], v1 offset:16384
	ds_read_b128 v[20:23], v1 offset:20480
	ds_read_b64_tr_b16 v[24:25], v5 offset:31296
	ds_read_b64_tr_b16 v[26:27], v5 offset:32064
	ds_read_b64_tr_b16 v[28:29], v48 offset:31296
	ds_read_b64_tr_b16 v[30:31], v49 offset:31296
	v_mfma_f32_32x32x16_bf16 v[64:79], v[40:43], v[32:35], v[64:79]
	s_lshr_b32 s59, 0x36112161, s42
	s_and_b32 s59, s59, 15
	s_add_u32 s59, s59, s58
	s_sub_u32 s60, s59, 10
	s_cselect_b32 s59, s59, s60
	s_mul_i32 s60, s59, 196608
	s_mul_i32 s61, s59, s62
	s_lshl_b32 s59, s59, 7
	s_add_u32 m0, s63, 0
	s_nop 0
	buffer_load_dwordx4 v7, s[4:7], s59 offen lds
	v_mfma_f32_32x32x16_bf16 v[80:95], v[40:43], v[36:39], v[80:95]
	v_mfma_f32_32x32x16_bf16 v[96:111], v[44:47], v[32:35], v[96:111]
	s_add_u32 m0, s63, 1024
	s_nop 0
	buffer_load_dwordx4 v8, s[4:7], s59 offen lds
	v_mfma_f32_32x32x16_bf16 v[112:127], v[44:47], v[36:39], v[112:127]
	ds_read_b128 v[32:35], v2 offset:16384
	ds_read_b128 v[36:39], v2 offset:20480
	ds_read_b64_tr_b16 v[40:41], v5 offset:34368
	ds_read_b64_tr_b16 v[42:43], v5 offset:35136
	ds_read_b64_tr_b16 v[44:45], v50 offset:31296
	ds_read_b64_tr_b16 v[46:47], v51 offset:31296
	s_waitcnt lgkmcnt(6)
	v_mfma_f32_32x32x16_bf16 v[64:79], v[24:27], v[16:19], v[64:79]
	s_add_u32 m0, s64, 0
	s_nop 0
	buffer_load_dwordx4 v9, s[8:11], s60 offen lds
	v_mfma_f32_32x32x16_bf16 v[80:95], v[24:27], v[20:23], v[80:95]
	v_mfma_f32_32x32x16_bf16 v[96:111], v[28:31], v[16:19], v[96:111]
	s_add_u32 m0, s64, 1024
	s_nop 0
	buffer_load_dwordx4 v10, s[8:11], s60 offen lds
	v_mfma_f32_32x32x16_bf16 v[112:127], v[28:31], v[20:23], v[112:127]
	ds_read_b128 v[16:19], v3 offset:16384
	ds_read_b128 v[20:23], v3 offset:20480
	ds_read_b64_tr_b16 v[24:25], v5 offset:37440
	ds_read_b64_tr_b16 v[26:27], v5 offset:38208
	ds_read_b64_tr_b16 v[28:29], v52 offset:31296
	ds_read_b64_tr_b16 v[30:31], v53 offset:31296
	s_waitcnt lgkmcnt(6)
	v_mfma_f32_32x32x16_bf16 v[64:79], v[40:43], v[32:35], v[64:79]
	s_add_u32 m0, s64, 2048
	s_nop 0
	buffer_load_dwordx4 v12, s[8:11], s60 offen lds
	v_mfma_f32_32x32x16_bf16 v[80:95], v[40:43], v[36:39], v[80:95]
	v_mfma_f32_32x32x16_bf16 v[96:111], v[44:47], v[32:35], v[96:111]
	s_add_u32 m0, s65, 0
	s_cbranch_vccnz U_9
	buffer_load_dwordx4 v13, s[12:15], s61 offen lds
	s_branch U_10
U_9:
	buffer_load_ushort v13, s[12:15], s61 offen lds
U_10:
	v_mfma_f32_32x32x16_bf16 v[112:127], v[44:47], v[36:39], v[112:127]
	ds_read_b128 v[32:35], v4 offset:16384
	ds_read_b128 v[36:39], v4 offset:20480
	ds_read_b64_tr_b16 v[40:41], v5 offset:40512
	ds_read_b64_tr_b16 v[42:43], v5 offset:41280
	ds_read_b64_tr_b16 v[44:45], v54 offset:31296
	ds_read_b64_tr_b16 v[46:47], v55 offset:31296
	s_waitcnt lgkmcnt(6)
	v_mfma_f32_32x32x16_bf16 v[64:79], v[24:27], v[16:19], v[64:79]
	v_mfma_f32_32x32x16_bf16 v[80:95], v[24:27], v[20:23], v[80:95]
	v_mfma_f32_32x32x16_bf16 v[96:111], v[28:31], v[16:19], v[96:111]
	v_mfma_f32_32x32x16_bf16 v[112:127], v[28:31], v[20:23], v[112:127]
	s_waitcnt lgkmcnt(0)
	s_waitcnt vmcnt(6)
	s_barrier
	ds_read_b128 v[16:19], v1 offset:32768
	ds_read_b128 v[20:23], v1 offset:36864
	ds_read_b64_tr_b16 v[24:25], v6 offset:0
	ds_read_b64_tr_b16 v[26:27], v6 offset:768
	ds_read_b64_tr_b16 v[28:29], v48 offset:62592
	ds_read_b64_tr_b16 v[30:31], v49 offset:62592
	v_mfma_f32_32x32x16_bf16 v[64:79], v[40:43], v[32:35], v[64:79]
	s_cmp_eq_u32 s16, 0
	s_cselect_b64 exec, 1, 0
	buffer_atomic_add v60, v61, s[28:31], s101 offen sc1
	s_mov_b64 exec, -1
	s_lshr_b32 s59, 0x74778828, s42
	s_and_b32 s59, s59, 15
	s_add_u32 s59, s59, s58
	s_sub_u32 s60, s59, 10
	s_cselect_b32 s59, s59, s60
	s_mul_i32 s60, s59, 196608
	s_mul_i32 s61, s59, s62
	s_lshl_b32 s59, s59, 7
	s_add_u32 m0, s63, 16384
	s_nop 0
	buffer_load_dwordx4 v7, s[4:7], s59 offen lds
	v_mfma_f32_32x32x16_bf16 v[80:95], v[40:43], v[36:39], v[80:95]
	v_mfma_f32_32x32x16_bf16 v[96:111], v[44:47], v[32:35], v[96:111]
	s_add_u32 m0, s63, 17408
	s_nop 0
	buffer_load_dwordx4 v8, s[4:7], s59 offen lds
	v_mfma_f32_32x32x16_bf16 v[112:127], v[44:47], v[36:39], v[112:127]
	ds_read_b128 v[32:35], v2 offset:32768
	ds_read_b128 v[36:39], v2 offset:36864
	ds_read_b64_tr_b16 v[40:41], v6 offset:3072
	ds_read_b64_tr_b16 v[42:43], v6 offset:3840
	ds_read_b64_tr_b16 v[44:45], v50 offset:62592
	ds_read_b64_tr_b16 v[46:47], v51 offset:62592
	s_waitcnt lgkmcnt(6)
	v_mfma_f32_32x32x16_bf16 v[64:79], v[24:27], v[16:19], v[64:79]
	s_add_u32 m0, s64, 31296
	s_nop 0
	buffer_load_dwordx4 v9, s[8:11], s60 offen lds
	v_mfma_f32_32x32x16_bf16 v[80:95], v[24:27], v[20:23], v[80:95]
	v_mfma_f32_32x32x16_bf16 v[96:111], v[28:31], v[16:19], v[96:111]
	s_add_u32 m0, s64, 32320
	s_nop 0
	buffer_load_dwordx4 v10, s[8:11], s60 offen lds
	v_mfma_f32_32x32x16_bf16 v[112:127], v[28:31], v[20:23], v[112:127]
	ds_read_b128 v[16:19], v3 offset:32768
	ds_read_b128 v[20:23], v3 offset:36864
	ds_read_b64_tr_b16 v[24:25], v6 offset:6144
	ds_read_b64_tr_b16 v[26:27], v6 offset:6912
	ds_read_b64_tr_b16 v[28:29], v52 offset:62592
	ds_read_b64_tr_b16 v[30:31], v53 offset:62592
	s_waitcnt lgkmcnt(6)
	v_mfma_f32_32x32x16_bf16 v[64:79], v[40:43], v[32:35], v[64:79]
	s_add_u32 m0, s64, 33344
	s_nop 0
	buffer_load_dwordx4 v12, s[8:11], s60 offen lds
	v_mfma_f32_32x32x16_bf16 v[80:95], v[40:43], v[36:39], v[80:95]
	v_mfma_f32_32x32x16_bf16 v[96:111], v[44:47], v[32:35], v[96:111]
	s_add_u32 m0, s65, 31296
	s_cbranch_vccnz U_11
	buffer_load_dwordx4 v13, s[12:15], s61 offen lds
	s_branch U_12
U_11:
	buffer_load_ushort v13, s[12:15], s61 offen lds
U_12:
	v_mfma_f32_32x32x16_bf16 v[112:127], v[44:47], v[36:39], v[112:127]
	ds_read_b128 v[32:35], v4 offset:32768
	ds_read_b128 v[36:39], v4 offset:36864
	ds_read_b64_tr_b16 v[40:41], v6 offset:9216
	ds_read_b64_tr_b16 v[42:43], v6 offset:9984
	ds_read_b64_tr_b16 v[44:45], v54 offset:62592
	ds_read_b64_tr_b16 v[46:47], v55 offset:62592
	s_waitcnt lgkmcnt(6)
	v_mfma_f32_32x32x16_bf16 v[64:79], v[24:27], v[16:19], v[64:79]
	v_mfma_f32_32x32x16_bf16 v[80:95], v[24:27], v[20:23], v[80:95]
	v_mfma_f32_32x32x16_bf16 v[96:111], v[28:31], v[16:19], v[96:111]
	v_mfma_f32_32x32x16_bf16 v[112:127], v[28:31], v[20:23], v[112:127]
	s_waitcnt lgkmcnt(0)
	s_waitcnt vmcnt(6)
	s_barrier
	ds_read_b128 v[16:19], v1 offset:0
	ds_read_b128 v[20:23], v1 offset:4096
	ds_read_b64_tr_b16 v[24:25], v5 offset:0
	ds_read_b64_tr_b16 v[26:27], v5 offset:768
	ds_read_b64_tr_b16 v[28:29], v48 offset:0
	ds_read_b64_tr_b16 v[30:31], v49 offset:0
	v_mfma_f32_32x32x16_bf16 v[64:79], v[40:43], v[32:35], v[64:79]
	s_lshr_b32 s59, 0x89664672, s42
	s_and_b32 s59, s59, 15
	s_add_u32 s59, s59, s58
	s_sub_u32 s60, s59, 10
	s_cselect_b32 s59, s59, s60
	s_mul_i32 s60, s59, 196608
	s_mul_i32 s61, s59, s62
	s_lshl_b32 s59, s59, 7
	s_add_u32 m0, s63, 32768
	s_nop 0
	buffer_load_dwordx4 v7, s[4:7], s59 offen lds
	v_mfma_f32_32x32x16_bf16 v[80:95], v[40:43], v[36:39], v[80:95]
	v_mfma_f32_32x32x16_bf16 v[96:111], v[44:47], v[32:35], v[96:111]
	s_add_u32 m0, s63, 33792
	s_nop 0
	buffer_load_dwordx4 v8, s[4:7], s59 offen lds
	v_mfma_f32_32x32x16_bf16 v[112:127], v[44:47], v[36:39], v[112:127]
	ds_read_b128 v[32:35], v2 offset:0
	ds_read_b128 v[36:39], v2 offset:4096
	ds_read_b64_tr_b16 v[40:41], v5 offset:3072
	ds_read_b64_tr_b16 v[42:43], v5 offset:3840
	ds_read_b64_tr_b16 v[44:45], v50 offset:0
	ds_read_b64_tr_b16 v[46:47], v51 offset:0
	s_waitcnt lgkmcnt(6)
	v_mfma_f32_32x32x16_bf16 v[64:79], v[24:27], v[16:19], v[64:79]
	s_add_u32 m0, s64, 62592
	s_nop 0
	buffer_load_dwordx4 v9, s[8:11], s60 offen lds
	v_mfma_f32_32x32x16_bf16 v[80:95], v[24:27], v[20:23], v[80:95]
	v_mfma_f32_32x32x16_bf16 v[96:111], v[28:31], v[16:19], v[96:111]
	s_add_u32 m0, s64, 63616
	s_nop 0
	buffer_load_dwordx4 v10, s[8:11], s60 offen lds
	v_mfma_f32_32x32x16_bf16 v[112:127], v[28:31], v[20:23], v[112:127]
	ds_read_b128 v[16:19], v3 offset:0
	ds_read_b128 v[20:23], v3 offset:4096
	ds_read_b64_tr_b16 v[24:25], v5 offset:6144
	ds_read_b64_tr_b16 v[26:27], v5 offset:6912
	ds_read_b64_tr_b16 v[28:29], v52 offset:0
	ds_read_b64_tr_b16 v[30:31], v53 offset:0
	s_waitcnt lgkmcnt(6)
	v_mfma_f32_32x32x16_bf16 v[64:79], v[40:43], v[32:35], v[64:79]
	s_add_u32 m0, s64, 64640
	s_nop 0
	buffer_load_dwordx4 v12, s[8:11], s60 offen lds
	v_mfma_f32_32x32x16_bf16 v[80:95], v[40:43], v[36:39], v[80:95]
	v_mfma_f32_32x32x16_bf16 v[96:111], v[44:47], v[32:35], v[96:111]
	s_add_u32 m0, s65, 62592
	s_cbranch_vccnz U_13
	buffer_load_dwordx4 v13, s[12:15], s61 offen lds
	s_branch U_14
U_13:
	buffer_load_ushort v13, s[12:15], s61 offen lds
U_14:
	v_mfma_f32_32x32x16_bf16 v[112:127], v[44:47], v[36:39], v[112:127]
	ds_read_b128 v[32:35], v4 offset:0
	ds_read_b128 v[36:39], v4 offset:4096
	ds_read_b64_tr_b16 v[40:41], v5 offset:9216
	ds_read_b64_tr_b16 v[42:43], v5 offset:9984
	ds_read_b64_tr_b16 v[44:45], v54 offset:0
	ds_read_b64_tr_b16 v[46:47], v55 offset:0
	s_waitcnt lgkmcnt(6)
	v_mfma_f32_32x32x16_bf16 v[64:79], v[24:27], v[16:19], v[64:79]
	v_mfma_f32_32x32x16_bf16 v[80:95], v[24:27], v[20:23], v[80:95]
	v_mfma_f32_32x32x16_bf16 v[96:111], v[28:31], v[16:19], v[96:111]
	v_mfma_f32_32x32x16_bf16 v[112:127], v[28:31], v[20:23], v[112:127]
	s_waitcnt lgkmcnt(0)
	s_waitcnt vmcnt(6)
	s_barrier
	ds_read_b128 v[16:19], v1 offset:16384
	ds_read_b128 v[20:23], v1 offset:20480
	ds_read_b64_tr_b16 v[24:25], v5 offset:31296
	ds_read_b64_tr_b16 v[26:27], v5 offset:32064
	ds_read_b64_tr_b16 v[28:29], v48 offset:31296
	ds_read_b64_tr_b16 v[30:31], v49 offset:31296
	v_mfma_f32_32x32x16_bf16 v[64:79], v[40:43], v[32:35], v[64:79]
	s_lshr_b32 s59, 0x43437446, s42
	s_and_b32 s59, s59, 15
	s_add_u32 s59, s59, s58
	s_sub_u32 s60, s59, 10
	s_cselect_b32 s59, s59, s60
	s_mul_i32 s60, s59, 196608
	s_mul_i32 s61, s59, s62
	s_lshl_b32 s59, s59, 7
	s_add_u32 m0, s63, 0
	s_nop 0
	buffer_load_dwordx4 v7, s[4:7], s59 offen lds
	v_mfma_f32_32x32x16_bf16 v[80:95], v[40:43], v[36:39], v[80:95]
	v_mfma_f32_32x32x16_bf16 v[96:111], v[44:47], v[32:35], v[96:111]
	s_add_u32 m0, s63, 1024
	s_nop 0
	buffer_load_dwordx4 v8, s[4:7], s59 offen lds
	v_mfma_f32_32x32x16_bf16 v[112:127], v[44:47], v[36:39], v[112:127]
	ds_read_b128 v[32:35], v2 offset:16384
	ds_read_b128 v[36:39], v2 offset:20480
	ds_read_b64_tr_b16 v[40:41], v5 offset:34368
	ds_read_b64_tr_b16 v[42:43], v5 offset:35136
	ds_read_b64_tr_b16 v[44:45], v50 offset:31296
	ds_read_b64_tr_b16 v[46:47], v51 offset:31296
	s_waitcnt lgkmcnt(6)
	v_mfma_f32_32x32x16_bf16 v[64:79], v[24:27], v[16:19], v[64:79]
	s_add_u32 m0, s64, 0
	s_nop 0
	buffer_load_dwordx4 v9, s[8:11], s60 offen lds
	v_mfma_f32_32x32x16_bf16 v[80:95], v[24:27], v[20:23], v[80:95]
	v_mfma_f32_32x32x16_bf16 v[96:111], v[28:31], v[16:19], v[96:111]
	s_add_u32 m0, s64, 1024
	s_nop 0
	buffer_load_dwordx4 v10, s[8:11], s60 offen lds
	v_mfma_f32_32x32x16_bf16 v[112:127], v[28:31], v[20:23], v[112:127]
	ds_read_b128 v[16:19], v3 offset:16384
	ds_read_b128 v[20:23], v3 offset:20480
	ds_read_b64_tr_b16 v[24:25], v5 offset:37440
	ds_read_b64_tr_b16 v[26:27], v5 offset:38208
	ds_read_b64_tr_b16 v[28:29], v52 offset:31296
	ds_read_b64_tr_b16 v[30:31], v53 offset:31296
	s_waitcnt lgkmcnt(6)
	v_mfma_f32_32x32x16_bf16 v[64:79], v[40:43], v[32:35], v[64:79]
	s_add_u32 m0, s64, 2048
	s_nop 0
	buffer_load_dwordx4 v12, s[8:11], s60 offen lds
	v_mfma_f32_32x32x16_bf16 v[80:95], v[40:43], v[36:39], v[80:95]
	v_mfma_f32_32x32x16_bf16 v[96:111], v[44:47], v[32:35], v[96:111]
	s_add_u32 m0, s65, 0
	s_cbranch_vccnz U_15
	buffer_load_dwordx4 v13, s[12:15], s61 offen lds
	s_branch U_16
U_15:
	buffer_load_ushort v13, s[12:15], s61 offen lds
U_16:
	v_mfma_f32_32x32x16_bf16 v[112:127], v[44:47], v[36:39], v[112:127]
	ds_read_b128 v[32:35], v4 offset:16384
	ds_read_b128 v[36:39], v4 offset:20480
	ds_read_b64_tr_b16 v[40:41], v5 offset:40512
	ds_read_b64_tr_b16 v[42:43], v5 offset:41280
	ds_read_b64_tr_b16 v[44:45], v54 offset:31296
	ds_read_b64_tr_b16 v[46:47], v55 offset:31296
	s_waitcnt lgkmcnt(6)
	v_mfma_f32_32x32x16_bf16 v[64:79], v[24:27], v[16:19], v[64:79]
	v_mfma_f32_32x32x16_bf16 v[80:95], v[24:27], v[20:23], v[80:95]
	v_mfma_f32_32x32x16_bf16 v[96:111], v[28:31], v[16:19], v[96:111]
	v_mfma_f32_32x32x16_bf16 v[112:127], v[28:31], v[20:23], v[112:127]
	s_waitcnt lgkmcnt(0)
	s_waitcnt vmcnt(6)
	s_barrier
	ds_read_b128 v[16:19], v1 offset:32768
	ds_read_b128 v[20:23], v1 offset:36864
	ds_read_b64_tr_b16 v[24:25], v6 offset:0
	ds_read_b64_tr_b16 v[26:27], v6 offset:768
	ds_read_b64_tr_b16 v[28:29], v48 offset:62592
	ds_read_b64_tr_b16 v[30:31], v49 offset:62592
	v_mfma_f32_32x32x16_bf16 v[64:79], v[40:43], v[32:35], v[64:79]
	s_lshr_b32 s59, 0x98989997, s42
	s_and_b32 s59, s59, 15
	s_add_u32 s59, s59, s58
	s_sub_u32 s60, s59, 10
	s_cselect_b32 s59, s59, s60
	s_mul_i32 s60, s59, 196608
	s_mul_i32 s61, s59, s62
	s_lshl_b32 s59, s59, 7
	s_add_u32 m0, s63, 16384
	s_nop 0
	buffer_load_dwordx4 v7, s[4:7], s59 offen lds
	v_mfma_f32_32x32x16_bf16 v[80:95], v[40:43], v[36:39], v[80:95]
	v_mfma_f32_32x32x16_bf16 v[96:111], v[44:47], v[32:35], v[96:111]
	s_add_u32 m0, s63, 17408
	s_nop 0
	buffer_load_dwordx4 v8, s[4:7], s59 offen lds
	v_mfma_f32_32x32x16_bf16 v[112:127], v[44:47], v[36:39], v[112:127]
	ds_read_b128 v[32:35], v2 offset:32768
	ds_read_b128 v[36:39], v2 offset:36864
	ds_read_b64_tr_b16 v[40:41], v6 offset:3072
	ds_read_b64_tr_b16 v[42:43], v6 offset:3840
	ds_read_b64_tr_b16 v[44:45], v50 offset:62592
	ds_read_b64_tr_b16 v[46:47], v51 offset:62592
	s_waitcnt lgkmcnt(6)
	v_mfma_f32_32x32x16_bf16 v[64:79], v[24:27], v[16:19], v[64:79]
	s_add_u32 m0, s64, 31296
	s_nop 0
	buffer_load_dwordx4 v9, s[8:11], s60 offen lds
	v_mfma_f32_32x32x16_bf16 v[80:95], v[24:27], v[20:23], v[80:95]
	v_mfma_f32_32x32x16_bf16 v[96:111], v[28:31], v[16:19], v[96:111]
	s_add_u32 m0, s64, 32320
	s_nop 0
	buffer_load_dwordx4 v10, s[8:11], s60 offen lds
	v_mfma_f32_32x32x16_bf16 v[112:127], v[28:31], v[20:23], v[112:127]
	ds_read_b128 v[16:19], v3 offset:32768
	ds_read_b128 v[20:23], v3 offset:36864
	ds_read_b64_tr_b16 v[24:25], v6 offset:6144
	ds_read_b64_tr_b16 v[26:27], v6 offset:6912
	ds_read_b64_tr_b16 v[28:29], v52 offset:62592
	ds_read_b64_tr_b16 v[30:31], v53 offset:62592
	s_waitcnt lgkmcnt(6)
	v_mfma_f32_32x32x16_bf16 v[64:79], v[40:43], v[32:35], v[64:79]
	s_add_u32 m0, s64, 33344
	s_nop 0
	buffer_load_dwordx4 v12, s[8:11], s60 offen lds
	v_mfma_f32_32x32x16_bf16 v[80:95], v[40:43], v[36:39], v[80:95]
	v_mfma_f32_32x32x16_bf16 v[96:111], v[44:47], v[32:35], v[96:111]
	s_add_u32 m0, s65, 31296
	s_cbranch_vccnz U_17
	buffer_load_dwordx4 v13, s[12:15], s61 offen lds
	s_branch U_18
U_17:
	buffer_load_ushort v13, s[12:15], s61 offen lds
U_18:
	v_mfma_f32_32x32x16_bf16 v[112:127], v[44:47], v[36:39], v[112:127]
	ds_read_b128 v[32:35], v4 offset:32768
	ds_read_b128 v[36:39], v4 offset:36864
	ds_read_b64_tr_b16 v[40:41], v6 offset:9216
	ds_read_b64_tr_b16 v[42:43], v6 offset:9984
	ds_read_b64_tr_b16 v[44:45], v54 offset:62592
	ds_read_b64_tr_b16 v[46:47], v55 offset:62592
	s_waitcnt lgkmcnt(6)
	v_mfma_f32_32x32x16_bf16 v[64:79], v[24:27], v[16:19], v[64:79]
	v_mfma_f32_32x32x16_bf16 v[80:95], v[24:27], v[20:23], v[80:95]
	v_mfma_f32_32x32x16_bf16 v[96:111], v[28:31], v[16:19], v[96:111]
	v_mfma_f32_32x32x16_bf16 v[112:127], v[28:31], v[20:23], v[112:127]
	s_waitcnt lgkmcnt(0)
	s_waitcnt vmcnt(6)
	s_barrier
	ds_read_b128 v[16:19], v1 offset:0
	ds_read_b128 v[20:23], v1 offset:4096
	ds_read_b64_tr_b16 v[24:25], v5 offset:0
	ds_read_b64_tr_b16 v[26:27], v5 offset:768
	ds_read_b64_tr_b16 v[28:29], v48 offset:0
	ds_read_b64_tr_b16 v[30:31], v49 offset:0
	v_mfma_f32_32x32x16_bf16 v[64:79], v[40:43], v[32:35], v[64:79]
	s_lshr_b32 s59, 0x12341234, s42
	s_and_b32 s59, s59, 15
	s_add_u32 s59, s59, s58
	s_sub_u32 s60, s59, 10
	s_cselect_b32 s59, s59, s60
	s_mul_i32 s60, s59, 196608
	s_mul_i32 s61, s59, s62
	s_lshl_b32 s59, s59, 7
	s_add_u32 m0, s63, 32768
	s_nop 0
	buffer_load_dwordx4 v7, s[4:7], s59 offen lds
	v_mfma_f32_32x32x16_bf16 v[80:95], v[40:43], v[36:39], v[80:95]
	v_mfma_f32_32x32x16_bf16 v[96:111], v[44:47], v[32:35], v[96:111]
	s_add_u32 m0, s63, 33792
	s_nop 0
	buffer_load_dwordx4 v8, s[4:7], s59 offen lds
	v_mfma_f32_32x32x16_bf16 v[112:127], v[44:47], v[36:39], v[112:127]
	ds_read_b128 v[32:35], v2 offset:0
	ds_read_b128 v[36:39], v2 offset:4096
	ds_read_b64_tr_b16 v[40:41], v5 offset:3072
	ds_read_b64_tr_b16 v[42:43], v5 offset:3840
	ds_read_b64_tr_b16 v[44:45], v50 offset:0
	ds_read_b64_tr_b16 v[46:47], v51 offset:0
	s_waitcnt lgkmcnt(6)
	v_mfma_f32_32x32x16_bf16 v[64:79], v[24:27], v[16:19], v[64:79]
	s_add_u32 m0, s64, 62592
	s_nop 0
	buffer_load_dwordx4 v9, s[8:11], s60 offen lds
	v_mfma_f32_32x32x16_bf16 v[80:95], v[24:27], v[20:23], v[80:95]
	v_mfma_f32_32x32x16_bf16 v[96:111], v[28:31], v[16:19], v[96:111]
	s_add_u32 m0, s64, 63616
	s_nop 0
	buffer_load_dwordx4 v10, s[8:11], s60 offen lds
	v_mfma_f32_32x32x16_bf16 v[112:127], v[28:31], v[20:23], v[112:127]
	ds_read_b128 v[16:19], v3 offset:0
	ds_read_b128 v[20:23], v3 offset:4096
	ds_read_b64_tr_b16 v[24:25], v5 offset:6144
	ds_read_b64_tr_b16 v[26:27], v5 offset:6912
	ds_read_b64_tr_b16 v[28:29], v52 offset:0
	ds_read_b64_tr_b16 v[30:31], v53 offset:0
	s_waitcnt lgkmcnt(6)
	v_mfma_f32_32x32x16_bf16 v[64:79], v[40:43], v[32:35], v[64:79]
	s_add_u32 m0, s64, 64640
	s_nop 0
	buffer_load_dwordx4 v12, s[8:11], s60 offen lds
	v_mfma_f32_32x32x16_bf16 v[80:95], v[40:43], v[36:39], v[80:95]
	v_mfma_f32_32x32x16_bf16 v[96:111], v[44:47], v[32:35], v[96:111]
	s_add_u32 m0, s65, 62592
	s_cbranch_vccnz U_19
	buffer_load_dwordx4 v13, s[12:15], s61 offen lds
	s_branch U_20
U_19:
	buffer_load_ushort v13, s[12:15], s61 offen lds
U_20:
	v_mfma_f32_32x32x16_bf16 v[112:127], v[44:47], v[36:39], v[112:127]
	ds_read_b128 v[32:35], v4 offset:0
	ds_read_b128 v[36:39], v4 offset:4096
	ds_read_b64_tr_b16 v[40:41], v5 offset:9216
	ds_read_b64_tr_b16 v[42:43], v5 offset:9984
	ds_read_b64_tr_b16 v[44:45], v54 offset:0
	ds_read_b64_tr_b16 v[46:47], v55 offset:0
	s_waitcnt lgkmcnt(6)
	v_mfma_f32_32x32x16_bf16 v[64:79], v[24:27], v[16:19], v[64:79]
	v_mfma_f32_32x32x16_bf16 v[80:95], v[24:27], v[20:23], v[80:95]
	v_mfma_f32_32x32x16_bf16 v[96:111], v[28:31], v[16:19], v[96:111]
	v_mfma_f32_32x32x16_bf16 v[112:127], v[28:31], v[20:23], v[112:127]
	s_waitcnt lgkmcnt(0)
	s_waitcnt vmcnt(6)
	s_barrier
	ds_read_b128 v[16:19], v1 offset:16384
	ds_read_b128 v[20:23], v1 offset:20480
	ds_read_b64_tr_b16 v[24:25], v5 offset:31296
	ds_read_b64_tr_b16 v[26:27], v5 offset:32064
	ds_read_b64_tr_b16 v[28:29], v48 offset:31296
	ds_read_b64_tr_b16 v[30:31], v49 offset:31296
	v_mfma_f32_32x32x16_bf16 v[64:79], v[40:43], v[32:35], v[64:79]
	s_lshr_b32 s59, 0x67896789, s42
	s_and_b32 s59, s59, 15
	s_add_u32 s59, s59, s58
	s_sub_u32 s60, s59, 10
	s_cselect_b32 s59, s59, s60
	s_mul_i32 s60, s59, 196608
	s_mul_i32 s61, s59, s62
	s_lshl_b32 s59, s59, 7
	s_add_u32 m0, s63, 0
	s_nop 0
	buffer_load_dwordx4 v7, s[4:7], s59 offen lds
	buffer_load_dword v139, v138, s[28:31], 0 offen sc1
	v_mfma_f32_32x32x16_bf16 v[80:95], v[40:43], v[36:39], v[80:95]
	v_mfma_f32_32x32x16_bf16 v[96:111], v[44:47], v[32:35], v[96:111]
	s_add_u32 m0, s63, 1024
	s_nop 0
	buffer_load_dwordx4 v8, s[4:7], s59 offen lds
	v_mfma_f32_32x32x16_bf16 v[112:127], v[44:47], v[36:39], v[112:127]
	ds_read_b128 v[32:35], v2 offset:16384
	ds_read_b128 v[36:39], v2 offset:20480
	ds_read_b64_tr_b16 v[40:41], v5 offset:34368
	ds_read_b64_tr_b16 v[42:43], v5 offset:35136
	ds_read_b64_tr_b16 v[44:45], v50 offset:31296
	ds_read_b64_tr_b16 v[46:47], v51 offset:31296
	s_waitcnt lgkmcnt(6)
	v_mfma_f32_32x32x16_bf16 v[64:79], v[24:27], v[16:19], v[64:79]
	s_add_u32 m0, s64, 0
	s_nop 0
	buffer_load_dwordx4 v9, s[8:11], s60 offen lds
	v_mfma_f32_32x32x16_bf16 v[80:95], v[24:27], v[20:23], v[80:95]
	v_mfma_f32_32x32x16_bf16 v[96:111], v[28:31], v[16:19], v[96:111]
	s_add_u32 m0, s64, 1024
	s_nop 0
	buffer_load_dwordx4 v10, s[8:11], s60 offen lds
	v_mfma_f32_32x32x16_bf16 v[112:127], v[28:31], v[20:23], v[112:127]
	ds_read_b128 v[16:19], v3 offset:16384
	ds_read_b128 v[20:23], v3 offset:20480
	ds_read_b64_tr_b16 v[24:25], v5 offset:37440
	ds_read_b64_tr_b16 v[26:27], v5 offset:38208
	ds_read_b64_tr_b16 v[28:29], v52 offset:31296
	ds_read_b64_tr_b16 v[30:31], v53 offset:31296
	s_waitcnt lgkmcnt(6)
	v_mfma_f32_32x32x16_bf16 v[64:79], v[40:43], v[32:35], v[64:79]
	s_add_u32 m0, s64, 2048
	s_nop 0
	buffer_load_dwordx4 v12, s[8:11], s60 offen lds
	v_mfma_f32_32x32x16_bf16 v[80:95], v[40:43], v[36:39], v[80:95]
	v_mfma_f32_32x32x16_bf16 v[96:111], v[44:47], v[32:35], v[96:111]
	s_add_u32 m0, s65, 0
	s_cbranch_vccnz U_21
	buffer_load_dwordx4 v13, s[12:15], s61 offen lds
	s_branch U_22
U_21:
	buffer_load_ushort v13, s[12:15], s61 offen lds
U_22:
	v_mfma_f32_32x32x16_bf16 v[112:127], v[44:47], v[36:39], v[112:127]
	ds_read_b128 v[32:35], v4 offset:16384
	ds_read_b128 v[36:39], v4 offset:20480
	ds_read_b64_tr_b16 v[40:41], v5 offset:40512
	ds_read_b64_tr_b16 v[42:43], v5 offset:41280
	ds_read_b64_tr_b16 v[44:45], v54 offset:31296
	ds_read_b64_tr_b16 v[46:47], v55 offset:31296
	s_waitcnt lgkmcnt(6)
	v_mfma_f32_32x32x16_bf16 v[64:79], v[24:27], v[16:19], v[64:79]
	v_mfma_f32_32x32x16_bf16 v[80:95], v[24:27], v[20:23], v[80:95]
	v_mfma_f32_32x32x16_bf16 v[96:111], v[28:31], v[16:19], v[96:111]
	v_mfma_f32_32x32x16_bf16 v[112:127], v[28:31], v[20:23], v[112:127]
	s_waitcnt lgkmcnt(0)
	s_waitcnt vmcnt(5)
	s_barrier
	ds_read_b128 v[16:19], v1 offset:32768
	ds_read_b128 v[20:23], v1 offset:36864
	ds_read_b64_tr_b16 v[24:25], v6 offset:0
	ds_read_b64_tr_b16 v[26:27], v6 offset:768
	ds_read_b64_tr_b16 v[28:29], v48 offset:62592
	ds_read_b64_tr_b16 v[30:31], v49 offset:62592
	v_mfma_f32_32x32x16_bf16 v[64:79], v[40:43], v[32:35], v[64:79]
	v_cmp_ne_u32 s[66:67], 4, v139
	s_nop 1
	s_cmp_eq_u64 s[66:67], 0
	s_cbranch_scc0 SPIN_23
RET_24:
	v_mfma_f32_32x32x16_bf16 v[80:95], v[40:43], v[36:39], v[80:95]
	buffer_load_dwordx4 v[144:147], v133, s[24:27], s74 offen offset:0 sc1
	v_mfma_f32_32x32x16_bf16 v[96:111], v[44:47], v[32:35], v[96:111]
	v_mfma_f32_32x32x16_bf16 v[112:127], v[44:47], v[36:39], v[112:127]
	s_mov_b64 exec, 0xffffffff
	buffer_load_dwordx4 v[152:155], v133, s[24:27], s74 offen offset:512 sc1
	s_mov_b64 exec, -1
	ds_read_b128 v[32:35], v2 offset:32768
	ds_read_b128 v[36:39], v2 offset:36864
	ds_read_b64_tr_b16 v[40:41], v6 offset:3072
	ds_read_b64_tr_b16 v[42:43], v6 offset:3840
	ds_read_b64_tr_b16 v[44:45], v50 offset:62592
	ds_read_b64_tr_b16 v[46:47], v51 offset:62592
	s_waitcnt lgkmcnt(6)
	v_mfma_f32_32x32x16_bf16 v[64:79], v[24:27], v[16:19], v[64:79]
	v_mfma_f32_32x32x16_bf16 v[80:95], v[24:27], v[20:23], v[80:95]
	buffer_load_dwordx4 v[148:151], v133, s[24:27], s74 offen offset:256 sc1
	v_mfma_f32_32x32x16_bf16 v[96:111], v[28:31], v[16:19], v[96:111]
	v_mfma_f32_32x32x16_bf16 v[112:127], v[28:31], v[20:23], v[112:127]
	s_mov_b64 exec, s[72:73]
	buffer_load_dwordx4 v[156:159], v134, s[24:27], s74 offen offset:0 sc1
	s_mov_b64 exec, -1
	ds_read_b128 v[16:19], v3 offset:32768
	ds_read_b128 v[20:23], v3 offset:36864
	ds_read_b64_tr_b16 v[24:25], v6 offset:6144
	ds_read_b64_tr_b16 v[26:27], v6 offset:6912
	ds_read_b64_tr_b16 v[28:29], v52 offset:62592
	ds_read_b64_tr_b16 v[30:31], v53 offset:62592
	s_waitcnt lgkmcnt(6)
	v_mfma_f32_32x32x16_bf16 v[64:79], v[40:43], v[32:35], v[64:79]
	v_mfma_f32_32x32x16_bf16 v[80:95], v[40:43], v[36:39], v[80:95]
	buffer_load_dwordx4 v[172:175], v133, s[24:27], s75 offen offset:0 sc1
	v_mfma_f32_32x32x16_bf16 v[96:111], v[44:47], v[32:35], v[96:111]
	v_mfma_f32_32x32x16_bf16 v[112:127], v[44:47], v[36:39], v[112:127]
	s_mov_b64 exec, 0xffffffff
	buffer_load_dwordx4 v[180:183], v133, s[24:27], s75 offen offset:512 sc1
	s_mov_b64 exec, -1
	ds_read_b128 v[32:35], v4 offset:32768
	ds_read_b128 v[36:39], v4 offset:36864
	ds_read_b64_tr_b16 v[40:41], v6 offset:9216
	ds_read_b64_tr_b16 v[42:43], v6 offset:9984
	ds_read_b64_tr_b16 v[44:45], v54 offset:62592
	ds_read_b64_tr_b16 v[46:47], v55 offset:62592
	s_waitcnt lgkmcnt(6)
	v_mfma_f32_32x32x16_bf16 v[64:79], v[24:27], v[16:19], v[64:79]
	v_mfma_f32_32x32x16_bf16 v[80:95], v[24:27], v[20:23], v[80:95]
	s_mov_b64 exec, s[72:73]
	buffer_load_dwordx4 v[160:163], v134, s[24:27], s74 offen offset:1280 sc1
	s_mov_b64 exec, -1
	v_mfma_f32_32x32x16_bf16 v[96:111], v[28:31], v[16:19], v[96:111]
	v_mfma_f32_32x32x16_bf16 v[112:127], v[28:31], v[20:23], v[112:127]
	s_mov_b64 exec, s[72:73]
	buffer_load_dwordx4 v[164:167], v134, s[24:27], s74 offen offset:320 sc1
	s_mov_b64 exec, -1
	s_waitcnt lgkmcnt(0)
	s_waitcnt vmcnt(8)
	s_barrier
	ds_read_b128 v[16:19], v1 offset:0
	ds_read_b128 v[20:23], v1 offset:4096
	ds_read_b64_tr_b16 v[24:25], v5 offset:0
	ds_read_b64_tr_b16 v[26:27], v5 offset:768
	ds_read_b64_tr_b16 v[28:29], v48 offset:0
	ds_read_b64_tr_b16 v[30:31], v49 offset:0
	v_mfma_f32_32x32x16_bf16 v[64:79], v[40:43], v[32:35], v[64:79]
	v_mfma_f32_32x32x16_bf16 v[80:95], v[40:43], v[36:39], v[80:95]
	buffer_load_dwordx4 v[176:179], v133, s[24:27], s75 offen offset:256 sc1
	v_mfma_f32_32x32x16_bf16 v[96:111], v[44:47], v[32:35], v[96:111]
	v_mfma_f32_32x32x16_bf16 v[112:127], v[44:47], v[36:39], v[112:127]
	s_mov_b64 exec, s[72:73]
	buffer_load_dwordx4 v[168:171], v134, s[24:27], s74 offen offset:1600 sc1
	s_mov_b64 exec, -1
	ds_read_b128 v[32:35], v2 offset:0
	ds_read_b128 v[36:39], v2 offset:4096
	ds_read_b64_tr_b16 v[40:41], v5 offset:3072
	ds_read_b64_tr_b16 v[42:43], v5 offset:3840
	ds_read_b64_tr_b16 v[44:45], v50 offset:0
	ds_read_b64_tr_b16 v[46:47], v51 offset:0
	s_waitcnt lgkmcnt(6)
	v_mfma_f32_32x32x16_bf16 v[64:79], v[24:27], v[16:19], v[64:79]
	v_mfma_f32_32x32x16_bf16 v[80:95], v[24:27], v[20:23], v[80:95]
	s_mov_b64 exec, s[72:73]
	buffer_load_dwordx4 v[184:187], v134, s[24:27], s75 offen offset:0 sc1
	s_mov_b64 exec, -1
	v_mfma_f32_32x32x16_bf16 v[96:111], v[28:31], v[16:19], v[96:111]
	v_mfma_f32_32x32x16_bf16 v[112:127], v[28:31], v[20:23], v[112:127]
	buffer_load_dwordx4 v[200:203], v133, s[24:27], s76 offen offset:0 sc1
	ds_read_b128 v[16:19], v3 offset:0
	ds_read_b128 v[20:23], v3 offset:4096
	ds_read_b64_tr_b16 v[24:25], v5 offset:6144
	ds_read_b64_tr_b16 v[26:27], v5 offset:6912
	ds_read_b64_tr_b16 v[28:29], v52 offset:0
	ds_read_b64_tr_b16 v[30:31], v53 offset:0
	s_waitcnt lgkmcnt(6)
	v_mfma_f32_32x32x16_bf16 v[64:79], v[40:43], v[32:35], v[64:79]
	v_mfma_f32_32x32x16_bf16 v[80:95], v[40:43], v[36:39], v[80:95]
	s_mov_b64 exec, 0xffffffff
	buffer_load_dwordx4 v[208:211], v133, s[24:27], s76 offen offset:512 sc1
	s_mov_b64 exec, -1
	v_mfma_f32_32x32x16_bf16 v[96:111], v[44:47], v[32:35], v[96:111]
	v_mfma_f32_32x32x16_bf16 v[112:127], v[44:47], v[36:39], v[112:127]
	s_mov_b64 exec, s[72:73]
	buffer_load_dwordx4 v[188:191], v134, s[24:27], s75 offen offset:1280 sc1
	s_mov_b64 exec, -1
	ds_read_b128 v[32:35], v4 offset:0
	ds_read_b128 v[36:39], v4 offset:4096
	ds_read_b64_tr_b16 v[40:41], v5 offset:9216
	ds_read_b64_tr_b16 v[42:43], v5 offset:9984
	ds_read_b64_tr_b16 v[44:45], v54 offset:0
	ds_read_b64_tr_b16 v[46:47], v55 offset:0
	s_waitcnt lgkmcnt(6)
	v_mfma_f32_32x32x16_bf16 v[64:79], v[24:27], v[16:19], v[64:79]
	v_mfma_f32_32x32x16_bf16 v[80:95], v[24:27], v[20:23], v[80:95]
	s_mov_b64 exec, s[72:73]
	buffer_load_dwordx4 v[192:195], v134, s[24:27], s75 offen offset:320 sc1
	s_mov_b64 exec, -1
	v_mfma_f32_32x32x16_bf16 v[96:111], v[28:31], v[16:19], v[96:111]
	v_mfma_f32_32x32x16_bf16 v[112:127], v[28:31], v[20:23], v[112:127]
	buffer_load_dwordx4 v[204:207], v133, s[24:27], s76 offen offset:256 sc1
	s_waitcnt lgkmcnt(0)
	v_mfma_f32_32x32x16_bf16 v[64:79], v[40:43], v[32:35], v[64:79]
	v_mfma_f32_32x32x16_bf16 v[80:95], v[40:43], v[36:39], v[80:95]
	s_mov_b64 exec, s[72:73]
	buffer_load_dwordx4 v[196:199], v134, s[24:27], s75 offen offset:1600 sc1
	s_mov_b64 exec, -1
	v_mfma_f32_32x32x16_bf16 v[96:111], v[44:47], v[32:35], v[96:111]
	v_mfma_f32_32x32x16_bf16 v[112:127], v[44:47], v[36:39], v[112:127]
	s_mov_b64 exec, s[72:73]
	buffer_load_dwordx4 v[212:215], v134, s[24:27], s76 offen offset:0 sc1
	s_mov_b64 exec, -1
	s_lshl_b32 s66, s18, 1
	s_cmp_ge_u32 s19, 2
	s_cbranch_scc1 L_q2
	s_lshl_b32 s67, s19, 2
	s_add_u32 s66, s66, s67
	s_mul_i32 s66, s66, 1536
	s_add_u32 s66, s66, 151040
	v_add_u32 v56, s66, v14
	v_cvt_pk_bf16_f32 v16, v104, v105
	v_cvt_pk_bf16_f32 v17, v106, v107
	v_cvt_pk_bf16_f32 v18, v108, v109
	v_cvt_pk_bf16_f32 v19, v110, v111
	ds_write_b128 v56, v[16:19] offset:0
	v_cvt_pk_bf16_f32 v20, v120, v121
	v_cvt_pk_bf16_f32 v21, v122, v123
	v_cvt_pk_bf16_f32 v22, v124, v125
	v_cvt_pk_bf16_f32 v23, v126, v127
	ds_write_b128 v56, v[20:23] offset:1536
L_q2ret:
	v_pk_mul_f32 v[24:25], v[64:65], v[64:65]
	v_pk_mul_f32 v[26:27], v[66:67], v[66:67]
	v_pk_mul_f32 v[28:29], v[68:69], v[68:69]
	v_pk_mul_f32 v[30:31], v[70:71], v[70:71]
	v_pk_fma_f32 v[24:25], v[24:25], v[130:131], v[128:129]
	v_pk_fma_f32 v[26:27], v[26:27], v[130:131], v[128:129]
	v_pk_fma_f32 v[28:29], v[28:29], v[130:131], v[128:129]
	v_pk_fma_f32 v[30:31], v[30:31], v[130:131], v[128:129]
	buffer_load_dwordx4 v[228:231], v133, s[24:27], s77 offen offset:0 sc1
	v_pk_mul_f32 v[24:25], v[24:25], v[64:65]
	v_pk_mul_f32 v[26:27], v[26:27], v[66:67]
	v_pk_mul_f32 v[28:29], v[28:29], v[68:69]
	v_pk_mul_f32 v[30:31], v[30:31], v[70:71]
	v_exp_f32 v24, v24
	v_exp_f32 v25, v25
	v_exp_f32 v26, v26
	v_exp_f32 v27, v27
	s_mov_b64 exec, 0xffffffff
	buffer_load_dwordx4 v[236:239], v133, s[24:27], s77 offen offset:512 sc1
	s_mov_b64 exec, -1
	v_exp_f32 v28, v28
	v_exp_f32 v29, v29
	v_exp_f32 v30, v30
	v_exp_f32 v31, v31
	v_pk_mul_f32 v[72:73], v[72:73], v[64:65]
	v_pk_mul_f32 v[74:75], v[74:75], v[66:67]
	v_pk_mul_f32 v[76:77], v[76:77], v[68:69]
	v_pk_mul_f32 v[78:79], v[78:79], v[70:71]
	s_mov_b64 exec, s[72:73]
	buffer_load_dwordx4 v[216:219], v134, s[24:27], s76 offen offset:1280 sc1
	s_mov_b64 exec, -1
	v_pk_add_f32 v[24:25], v[24:25], v[62:63]
	v_pk_add_f32 v[26:27], v[26:27], v[62:63]
	v_pk_add_f32 v[28:29], v[28:29], v[62:63]
	v_pk_add_f32 v[30:31], v[30:31], v[62:63]
	v_rcp_f32 v24, v24
	v_rcp_f32 v25, v25
	v_rcp_f32 v26, v26
	v_rcp_f32 v27, v27
	s_mov_b64 exec, s[72:73]
	buffer_load_dwordx4 v[220:223], v134, s[24:27], s76 offen offset:320 sc1
	s_mov_b64 exec, -1
	v_rcp_f32 v28, v28
	v_rcp_f32 v29, v29
	v_rcp_f32 v30, v30
	v_rcp_f32 v31, v31
	v_pk_mul_f32 v[24:25], v[24:25], v[72:73]
	v_pk_mul_f32 v[26:27], v[26:27], v[74:75]
	v_pk_mul_f32 v[28:29], v[28:29], v[76:77]
	v_pk_mul_f32 v[30:31], v[30:31], v[78:79]
	buffer_load_dwordx4 v[232:235], v133, s[24:27], s77 offen offset:256 sc1
	v_cvt_pk_bf16_f32 v32, v24, v25
	v_cvt_pk_bf16_f32 v33, v26, v27
	v_cvt_pk_bf16_f32 v34, v28, v29
	v_cvt_pk_bf16_f32 v35, v30, v31
	v_pk_mul_f32 v[24:25], v[80:81], v[80:81]
	v_pk_mul_f32 v[26:27], v[82:83], v[82:83]
	v_pk_mul_f32 v[28:29], v[84:85], v[84:85]
	v_pk_mul_f32 v[30:31], v[86:87], v[86:87]
	v_pk_fma_f32 v[24:25], v[24:25], v[130:131], v[128:129]
	v_pk_fma_f32 v[26:27], v[26:27], v[130:131], v[128:129]
	v_pk_fma_f32 v[28:29], v[28:29], v[130:131], v[128:129]
	v_pk_fma_f32 v[30:31], v[30:31], v[130:131], v[128:129]
	s_mov_b64 exec, s[72:73]
	buffer_load_dwordx4 v[224:227], v134, s[24:27], s76 offen offset:1600 sc1
	s_mov_b64 exec, -1
	v_pk_mul_f32 v[24:25], v[24:25], v[80:81]
	v_pk_mul_f32 v[26:27], v[26:27], v[82:83]
	v_pk_mul_f32 v[28:29], v[28:29], v[84:85]
	v_pk_mul_f32 v[30:31], v[30:31], v[86:87]
	v_exp_f32 v24, v24
	v_exp_f32 v25, v25
	v_exp_f32 v26, v26
	v_exp_f32 v27, v27
	s_mov_b64 exec, s[72:73]
	buffer_load_dwordx4 v[240:243], v134, s[24:27], s77 offen offset:0 sc1
	s_mov_b64 exec, -1
	v_exp_f32 v28, v28
	v_exp_f32 v29, v29
	v_exp_f32 v30, v30
	v_exp_f32 v31, v31
	v_pk_mul_f32 v[88:89], v[88:89], v[80:81]
	v_pk_mul_f32 v[90:91], v[90:91], v[82:83]
	v_pk_mul_f32 v[92:93], v[92:93], v[84:85]
	v_pk_mul_f32 v[94:95], v[94:95], v[86:87]
	s_mov_b64 exec, s[72:73]
	buffer_load_dwordx4 v[244:247], v134, s[24:27], s77 offen offset:1280 sc1
	s_mov_b64 exec, -1
	v_pk_add_f32 v[24:25], v[24:25], v[62:63]
	v_pk_add_f32 v[26:27], v[26:27], v[62:63]
	v_pk_add_f32 v[28:29], v[28:29], v[62:63]
	v_pk_add_f32 v[30:31], v[30:31], v[62:63]
	v_rcp_f32 v24, v24
	v_rcp_f32 v25, v25
	v_rcp_f32 v26, v26
	v_rcp_f32 v27, v27
	s_mov_b64 exec, s[72:73]
	buffer_load_dwordx4 v[248:251], v134, s[24:27], s77 offen offset:320 sc1
	s_mov_b64 exec, -1
	v_rcp_f32 v28, v28
	v_rcp_f32 v29, v29
	v_rcp_f32 v30, v30
	v_rcp_f32 v31, v31
	v_pk_mul_f32 v[24:25], v[24:25], v[88:89]
	v_pk_mul_f32 v[26:27], v[26:27], v[90:91]
	v_pk_mul_f32 v[28:29], v[28:29], v[92:93]
	v_pk_mul_f32 v[30:31], v[30:31], v[94:95]
	s_mov_b64 exec, s[72:73]
	buffer_load_dwordx4 v[252:255], v134, s[24:27], s77 offen offset:1600 sc1
	s_mov_b64 exec, -1
	v_cvt_pk_bf16_f32 v36, v24, v25
	v_cvt_pk_bf16_f32 v37, v26, v27
	v_cvt_pk_bf16_f32 v38, v28, v29
	v_cvt_pk_bf16_f32 v39, v30, v31
	v_pk_mul_f32 v[24:25], v[96:97], v[96:97]
	v_pk_mul_f32 v[26:27], v[98:99], v[98:99]
	v_pk_mul_f32 v[28:29], v[112:113], v[112:113]
	v_pk_mul_f32 v[30:31], v[114:115], v[114:115]
	v_pk_fma_f32 v[24:25], v[24:25], v[130:131], v[128:129]
	v_pk_fma_f32 v[26:27], v[26:27], v[130:131], v[128:129]
	v_pk_fma_f32 v[28:29], v[28:29], v[130:131], v[128:129]
	v_pk_fma_f32 v[30:31], v[30:31], v[130:131], v[128:129]
	v_pk_mul_f32 v[24:25], v[24:25], v[96:97]
	v_pk_mul_f32 v[26:27], v[26:27], v[98:99]
	v_pk_mul_f32 v[28:29], v[28:29], v[112:113]
	v_pk_mul_f32 v[30:31], v[30:31], v[114:115]
	v_exp_f32 v24, v24
	v_exp_f32 v25, v25
	v_exp_f32 v26, v26
	v_exp_f32 v27, v27
	v_exp_f32 v28, v28
	v_exp_f32 v29, v29
	v_exp_f32 v30, v30
	v_exp_f32 v31, v31
	v_pk_mul_f32 v[100:101], v[100:101], v[96:97]
	v_pk_mul_f32 v[102:103], v[102:103], v[98:99]
	v_pk_mul_f32 v[116:117], v[116:117], v[112:113]
	v_pk_mul_f32 v[118:119], v[118:119], v[114:115]
	v_pk_add_f32 v[24:25], v[24:25], v[62:63]
	v_pk_add_f32 v[26:27], v[26:27], v[62:63]
	v_pk_add_f32 v[28:29], v[28:29], v[62:63]
	v_pk_add_f32 v[30:31], v[30:31], v[62:63]
	v_rcp_f32 v24, v24
	v_rcp_f32 v25, v25
	v_rcp_f32 v26, v26
	v_rcp_f32 v27, v27
	v_rcp_f32 v28, v28
	v_rcp_f32 v29, v29
	v_rcp_f32 v30, v30
	v_rcp_f32 v31, v31
	v_pk_mul_f32 v[24:25], v[24:25], v[100:101]
	v_pk_mul_f32 v[26:27], v[26:27], v[102:103]
	v_pk_mul_f32 v[28:29], v[28:29], v[116:117]
	v_pk_mul_f32 v[30:31], v[30:31], v[118:119]
	v_cvt_pk_bf16_f32 v40, v24, v25
	v_cvt_pk_bf16_f32 v41, v26, v27
	v_cvt_pk_bf16_f32 v42, v28, v29
	v_cvt_pk_bf16_f32 v43, v30, v31
	buffer_store_dwordx4 v[32:35], v135, s[24:27], s78 offen sc1
	buffer_store_dwordx4 v[36:39], v135, s[24:27], s79 offen sc1
	v_permlane32_swap_b32 v40, v42
	v_permlane32_swap_b32 v41, v43
	buffer_store_dwordx4 v[40:43], v136, s[24:27], s78 offen offset:512 sc1
	v_lshlrev_b32 v4, 3, v11
	s_mul_i32 s66, s16, 1536
	s_add_u32 s66, s66, 151040
	v_add_u32 v2, s66, v14
	v_add_u32 v3, s66, v4
	v_mov_b32 v80, 0
	v_mov_b32 v81, 0
	v_mov_b32 v87, 0xdddddddd
	v_mov_b64 v[16:17], 0
	v_mov_b64 v[18:19], 0
	v_mov_b64 v[20:21], 0
	v_mov_b64 v[22:23], 0
	v_mov_b64 v[24:25], 0
	v_mov_b64 v[26:27], 0
	v_mov_b64 v[28:29], 0
	v_mov_b64 v[30:31], 0
	s_waitcnt lgkmcnt(0)
	s_barrier
	ds_read_b128 v[88:91], v2
	ds_read_b64 v[92:93], v3 offset:1024
	s_mov_b32 s68, 0
	s_mov_b32 s69, -1
	s_waitcnt vmcnt(29) lgkmcnt(1)
	v_mfma_f32_32x32x16_bf16 v[48:63], v[144:147], v[88:91], 0
	s_mov_b64 exec, s[68:69]
	s_waitcnt lgkmcnt(0)
	v_mov_b32 v92, 0
	v_mov_b32 v93, 0
	s_mov_b64 exec, -1
	s_nop 0
	v_mfma_f32_32x32x8_bf16 v[48:63], v[152:153], v[92:93], v[48:63]
	s_mul_i32 s66, s16, 3072
	s_add_u32 s66, s66, 122880
	v_add_u32 v1, s66, v14
	s_lshr_b32 s66, s17, 3
	s_and_b32 s67, s17, 3
	s_lshl2_add_u32 s66, s66, s67
	s_mul_i32 s43, s66, 160
	s_sub_u32 s67, 1966080, s43
	s_add_u32 s20, s48, s43
	s_addc_u32 s21, s49, 0
	s_mov_b32 s22, s67
	s_mov_b32 s23, 0x00020000
	s_sub_u32 s67, 819200, s43
	s_add_u32 s28, s40, s43
	s_addc_u32 s29, s41, 0
	s_mov_b32 s30, s67
	s_mov_b32 s31, 0x00020000
	v_max3_f32 v13, v48, v49, v50
	v_max3_f32 v12, v51, v52, v53
	v_max3_f32 v13, v13, v54, v55
	v_max3_f32 v12, v12, v56, v57
	v_max3_f32 v13, v13, v58, v59
	v_max3_f32 v12, v12, v60, v61
	v_max3_f32 v13, v13, v62, v63
	v_max_f32 v13, v13, v12
	v_mov_b32 v12, v13
	s_nop 1
	v_permlane32_swap_b32 v13, v12
	v_max_f32 v13, v13, v12
	v_and_b32 v12, 0xffff0000, v13
	v_sub_f32 v13, v13, v12
	s_mov_b64 exec, s[68:69]
	v_cvt_pk_bf16_f32 v80, -v12, -v13
	v_mov_b32 v92, v80
	ds_write_b64 v3, v[80:81] offset:1024
	s_mov_b64 exec, -1
	v_mfma_f32_32x32x8_bf16 v[48:63], v[152:153], v[80:81], v[48:63]
	s_mul_i32 s58, s18, 163840
	s_mul_i32 s66, s19, 40960
	s_add_u32 s58, s58, s66
	s_mul_i32 s59, s18, 20480
	s_mul_i32 s66, s19, 5120
	s_add_u32 s59, s59, s66
	s_lshl_b32 s62, s3, 1
	s_bfe_u32 s66, s17, 0x10002
	s_add_u32 s62, s62, s66
	s_lshl_b32 s62, s62, 1
	s_add_u32 s62, s62, s18
	s_mul_i32 s60, s62, 98304
	s_lshr_b32 s66, s19, 1
	s_lshl_b32 s66, s66, 11
	s_add_u32 s60, s60, s66
	s_add_u32 s60, s60, 1048576
	s_lshl_b32 s61, s3, 11
	s_add_u32 s61, s61, 262144
	s_mov_b64 s[74:75], -1
	s_nop 3
.p2align 3
L_attn:
	v_exp_f32 v48, v48
	s_waitcnt vmcnt(3)
	s_setprio 3
	v_exp_f32 v49, v49
	v_exp_f32 v50, v50
	v_exp_f32 v51, v51
	v_exp_f32 v52, v52
	v_exp_f32 v53, v53
	v_mfma_f32_32x32x16_bf16 v[64:79], v[148:151], v[88:91], 0
	v_exp_f32 v54, v54
	v_exp_f32 v55, v55
	v_exp_f32 v56, v56
	v_exp_f32 v57, v57
	v_mfma_f32_32x32x8_bf16 v[64:79], v[154:155], v[92:93], v[64:79]
	v_exp_f32 v58, v58
	v_exp_f32 v59, v59
	v_exp_f32 v60, v60
	v_exp_f32 v61, v61
	v_smfmac_f32_32x32x32_bf16 v[16:31], v[156:159], v[48:55], v87
	v_exp_f32 v62, v62
	v_exp_f32 v63, v63
	v_exp_f32 v64, v64
	v_exp_f32 v65, v65
	v_smfmac_f32_32x32x32_bf16 v[16:31], v[160:163], v[56:63], v87
	v_exp_f32 v66, v66
	v_exp_f32 v67, v67
	v_exp_f32 v68, v68
	v_exp_f32 v69, v69
	v_mfma_f32_32x32x16_bf16 v[48:63], v[172:175], v[88:91], 0
	s_and_b32 s66, s19, 1
	s_mul_i32 s66, s66, 49152
	v_add_u32 v5, s66, v14
	s_sub_u32 s66, 49152, s66
	v_add_u32 v6, s66, v14
	v_exp_f32 v70, v70
	v_exp_f32 v71, v71
	v_exp_f32 v72, v72
	v_exp_f32_e64 v73, v73
	v_mfma_f32_32x32x8_bf16 v[48:63], v[180:181], v[92:93], v[48:63]
	v_and_b32 v7, 15, v11
	v_lshlrev_b32 v7, 7, v7
	v_mov_b32 v8, 1
	s_lshl_b32 s63, s17, 7
	s_add_u32 s63, s63, s61
	v_exp_f32 v74, v74
	v_exp_f32 v75, v75
	v_exp_f32 v76, v76
	v_exp_f32_e64 v77, v77
	v_smfmac_f32_32x32x32_bf16 v[16:31], v[164:167], v[64:71], v87
	v_exp_f32 v78, v78
	v_exp_f32 v79, v79
	v_exp_f32 v48, v48
	v_exp_f32 v49, v49
	v_smfmac_f32_32x32x32_bf16 v[16:31], v[168:171], v[72:79], v87
	v_exp_f32 v50, v50
	v_exp_f32 v51, v51
	v_exp_f32 v52, v52
	s_setprio 2
	v_exp_f32_e64 v53, v53
	v_mfma_f32_32x32x16_bf16 v[64:79], v[176:179], v[88:91], 0
	v_mov_b32 v100, -1
	v_mov_b32 v101, -1
	v_mov_b32 v102, -1
	v_mov_b32 v103, -1
	s_lshl_b32 s66, s3, 3
	s_add_u32 s66, s66, s16
	s_mul_i32 s66, s66, 20480
	s_lshl_b32 s67, s17, 10
	s_add_u32 s66, s66, 7340032
	s_add_u32 s64, s66, s67
	s_lshl_b32 s67, s17, 8
	s_add_u32 s65, s66, s67
	s_add_u32 s65, s65, 16384
	v_exp_f32 v54, v54
	v_exp_f32 v55, v55
	v_exp_f32 v56, v56
	v_exp_f32 v57, v57
	v_mfma_f32_32x32x8_bf16 v[64:79], v[182:183], v[92:93], v[64:79]
	v_exp_f32 v58, v58
	v_exp_f32 v59, v59
	v_exp_f32 v60, v60
	v_exp_f32 v61, v61
	v_smfmac_f32_32x32x32_bf16 v[16:31], v[184:187], v[48:55], v87
	v_exp_f32 v62, v62
	v_exp_f32 v63, v63
	v_exp_f32 v64, v64
	v_exp_f32 v65, v65
	v_smfmac_f32_32x32x32_bf16 v[16:31], v[188:191], v[56:63], v87
	s_add_u32 s66, s16, 1
	s_and_b32 s66, s66, 7
	s_mul_i32 s66, s66, 1536
	s_add_u32 s66, s66, 151040
	v_add_u32 v2, s66, v14
	v_add_u32 v3, s66, v4
	v_mov_b64 v[32:33], 0
	v_exp_f32 v66, v66
	v_exp_f32 v67, v67
	v_exp_f32 v68, v68
	s_setprio 1
	v_exp_f32 v69, v69
	v_mfma_f32_32x32x16_bf16 v[48:63], v[200:203], v[88:91], 0
	v_mov_b64 v[34:35], 0
	v_exp_f32 v70, v70
	v_exp_f32 v71, v71
	v_exp_f32 v72, v72
	v_exp_f32_e64 v73, v73
	v_mfma_f32_32x32x8_bf16 v[48:63], v[208:209], v[92:93], v[48:63]
	v_mov_b64 v[36:37], 0
	v_exp_f32 v74, v74
	v_exp_f32 v75, v75
	v_exp_f32 v76, v76
	s_setprio 0
	v_exp_f32 v77, v77
	v_smfmac_f32_32x32x32_bf16 v[16:31], v[192:195], v[64:71], v87
	v_mov_b64 v[38:39], 0
	v_exp_f32 v78, v78
	v_exp_f32 v79, v79
	v_exp_f32 v48, v48
	s_waitcnt lgkmcnt(0)
	s_barrier
	v_exp_f32_e64 v49, v49
	v_smfmac_f32_32x32x32_bf16 v[16:31], v[196:199], v[72:79], v87
	v_mov_b64 v[40:41], 0
	v_exp_f32 v50, v50
	s_setprio 3
	v_exp_f32 v51, v51
	v_exp_f32 v52, v52
	v_exp_f32 v53, v53
	v_mfma_f32_32x32x16_bf16 v[64:79], v[204:207], v[88:91], 0
	v_mov_b64 v[42:43], 0
	v_exp_f32 v54, v54
	v_exp_f32 v55, v55
	v_exp_f32 v56, v56
	v_exp_f32_e64 v57, v57
	v_mfma_f32_32x32x8_bf16 v[64:79], v[210:211], v[92:93], v[64:79]
	v_mov_b64 v[44:45], 0
	v_exp_f32 v58, v58
	v_exp_f32 v59, v59
	v_exp_f32 v60, v60
	v_exp_f32_e64 v61, v61
	v_smfmac_f32_32x32x32_bf16 v[16:31], v[212:215], v[48:55], v87
	v_mov_b64 v[46:47], 0
	v_exp_f32 v62, v62
	v_exp_f32 v63, v63
	v_exp_f32 v64, v64
	v_exp_f32_e64 v65, v65
	v_smfmac_f32_32x32x32_bf16 v[16:31], v[216:219], v[56:63], v87
	v_exp_f32 v66, v66
	v_exp_f32 v67, v67
	v_exp_f32 v68, v68
	v_exp_f32 v69, v69
	v_mfma_f32_32x32x16_bf16 v[48:63], v[228:231], v[88:91], 0
	v_exp_f32 v70, v70
	v_exp_f32 v71, v71
	v_exp_f32 v72, v72
	v_exp_f32 v73, v73
	v_mfma_f32_32x32x8_bf16 v[48:63], v[236:237], v[92:93], v[48:63]
	v_exp_f32 v74, v74
	v_exp_f32 v75, v75
	v_exp_f32 v76, v76
	v_exp_f32 v77, v77
	v_smfmac_f32_32x32x32_bf16 v[16:31], v[220:223], v[64:71], v87
	v_exp_f32 v78, v78
	v_exp_f32 v79, v79
	v_exp_f32 v48, v48
	v_exp_f32 v49, v49
	v_smfmac_f32_32x32x32_bf16 v[16:31], v[224:227], v[72:79], v87
	ds_read_b128 v[94:97], v2
	v_exp_f32 v50, v50
	v_exp_f32 v51, v51
	v_exp_f32 v52, v52
	v_exp_f32 v53, v53
	v_mfma_f32_32x32x16_bf16 v[64:79], v[232:235], v[88:91], 0
	ds_read_b64 v[98:99], v3 offset:1024
	v_exp_f32 v54, v54
	v_exp_f32 v55, v55
	v_exp_f32 v56, v56
	v_exp_f32 v57, v57
	v_mfma_f32_32x32x8_bf16 v[64:79], v[238:239], v[92:93], v[64:79]
	buffer_store_dwordx4 v[100:103], v14, s[24:27], s64 offen sc1
	v_exp_f32 v58, v58
	v_exp_f32 v59, v59
	v_exp_f32 v60, v60
	v_exp_f32 v61, v61
	v_smfmac_f32_32x32x32_bf16 v[16:31], v[240:243], v[48:55], v87
	s_mov_b64 exec, 0xffff
	buffer_store_dwordx4 v[100:103], v14, s[24:27], s65 offen sc1
	s_mov_b64 exec, -1
	v_exp_f32 v62, v62
	v_exp_f32 v63, v63
	v_exp_f32 v64, v64
	s_waitcnt lgkmcnt(0)
	v_exp_f32 v65, v65
	v_smfmac_f32_32x32x32_bf16 v[16:31], v[244:247], v[56:63], v87
	v_exp_f32 v66, v66
	v_exp_f32 v67, v67
	v_exp_f32 v68, v68
	v_exp_f32 v69, v69
	v_mfma_f32_32x32x16_bf16 v[48:63], v[144:147], v[94:97], 0
	v_exp_f32 v70, v70
	v_exp_f32 v71, v71
	v_exp_f32 v72, v72
	v_exp_f32 v73, v73
	v_mfma_f32_32x32x8_bf16 v[48:63], v[152:153], v[98:99], v[48:63]
	v_exp_f32 v74, v74
	v_exp_f32 v75, v75
	v_exp_f32 v76, v76
	v_exp_f32 v77, v77
	v_smfmac_f32_32x32x32_bf16 v[16:31], v[248:251], v[64:71], v87
	v_exp_f32 v78, v78
	v_exp_f32 v79, v79
	v_exp_f32 v48, v48
	s_waitcnt vmcnt(0)
	v_exp_f32_e64 v49, v49
	v_smfmac_f32_32x32x32_bf16 v[16:31], v[252:255], v[72:79], v87
	v_exp_f32 v50, v50
	v_exp_f32 v51, v51
	v_exp_f32 v52, v52
	v_exp_f32 v53, v53
	v_mfma_f32_32x32x16_bf16 v[64:79], v[148:151], v[94:97], 0
	v_exp_f32 v54, v54
	v_exp_f32 v55, v55
	v_exp_f32 v56, v56
	v_exp_f32 v57, v57
	v_mfma_f32_32x32x8_bf16 v[64:79], v[154:155], v[98:99], v[64:79]
	v_exp_f32 v58, v58
	v_exp_f32 v59, v59
	v_exp_f32 v60, v60
	v_exp_f32 v61, v61
	v_smfmac_f32_32x32x32_bf16 v[32:47], v[156:159], v[48:55], v87
	v_exp_f32 v62, v62
	v_exp_f32 v63, v63
	v_exp_f32 v64, v64
	s_setprio 2
	v_exp_f32_e64 v65, v65
	v_smfmac_f32_32x32x32_bf16 v[32:47], v[160:163], v[56:63], v87
	ds_write_b128 v1, v[16:19] offset:0
	v_exp_f32 v66, v66
	v_exp_f32 v67, v67
	v_exp_f32 v68, v68
	v_exp_f32 v69, v69
	v_mfma_f32_32x32x16_bf16 v[48:63], v[172:175], v[94:97], 0
	ds_write_b128 v1, v[20:23] offset:1024
	v_exp_f32 v70, v70
	v_exp_f32 v71, v71
	v_exp_f32 v72, v72
	v_exp_f32 v73, v73
	v_mfma_f32_32x32x8_bf16 v[48:63], v[180:181], v[98:99], v[48:63]
	ds_write_b128 v1, v[24:27] offset:2048
	v_exp_f32 v74, v74
	v_exp_f32 v75, v75
	v_exp_f32 v76, v76
	v_exp_f32 v77, v77
	v_smfmac_f32_32x32x32_bf16 v[32:47], v[164:167], v[64:71], v87
	v_exp_f32 v78, v78
	v_exp_f32 v79, v79
	v_exp_f32 v48, v48
	v_exp_f32 v49, v49
	v_smfmac_f32_32x32x32_bf16 v[32:47], v[168:171], v[72:79], v87
	s_add_u32 s66, s16, 2
	s_and_b32 s66, s66, 7
	s_mul_i32 s66, s66, 3072
	s_add_u32 s66, s66, 122880
	v_add_u32 v1, s66, v14
	v_exp_f32 v50, v50
	v_exp_f32 v51, v51
	v_exp_f32 v52, v52
	v_exp_f32_e64 v53, v53
	v_mfma_f32_32x32x16_bf16 v[64:79], v[176:179], v[94:97], 0
	v_exp_f32 v54, v54
	v_exp_f32 v55, v55
	v_exp_f32 v56, v56
	v_exp_f32 v57, v57
	v_mfma_f32_32x32x8_bf16 v[64:79], v[182:183], v[98:99], v[64:79]
	v_exp_f32 v58, v58
	v_exp_f32 v59, v59
	v_exp_f32 v60, v60
	s_setprio 1
	v_exp_f32_e64 v61, v61
	v_smfmac_f32_32x32x32_bf16 v[32:47], v[184:187], v[48:55], v87
	v_exp_f32 v62, v62
	v_exp_f32 v63, v63
	v_exp_f32 v64, v64
	v_exp_f32 v65, v65
	v_smfmac_f32_32x32x32_bf16 v[32:47], v[188:191], v[56:63], v87
	s_add_u32 s66, s16, 2
	s_and_b32 s66, s66, 7
	s_mul_i32 s66, s66, 1536
	s_add_u32 s66, s66, 151040
	v_add_u32 v2, s66, v14
	v_add_u32 v3, s66, v4
	v_exp_f32 v66, v66
	v_exp_f32 v67, v67
	v_exp_f32 v68, v68
	v_exp_f32 v69, v69
	v_mfma_f32_32x32x16_bf16 v[48:63], v[200:203], v[94:97], 0
	v_exp_f32 v70, v70
	v_exp_f32 v71, v71
	v_exp_f32 v72, v72
	s_setprio 0
	v_exp_f32_e64 v73, v73
	v_mfma_f32_32x32x8_bf16 v[48:63], v[208:209], v[98:99], v[48:63]
	v_exp_f32 v74, v74
	v_exp_f32 v75, v75
	v_exp_f32 v76, v76
	v_exp_f32 v77, v77
	v_smfmac_f32_32x32x32_bf16 v[32:47], v[192:195], v[64:71], v87
	v_exp_f32 v78, v78
	v_exp_f32 v79, v79
	v_exp_f32 v48, v48
	s_waitcnt lgkmcnt(0)
	s_barrier
	v_exp_f32 v49, v49
	v_smfmac_f32_32x32x32_bf16 v[32:47], v[196:199], v[72:79], v87
	v_exp_f32 v50, v50
	s_setprio 3
	v_exp_f32 v51, v51
	v_exp_f32 v52, v52
	v_exp_f32_e64 v53, v53
	v_mfma_f32_32x32x16_bf16 v[64:79], v[204:207], v[94:97], 0
	s_cmp_eq_u32 s16, 0
	s_cselect_b64 exec, 1, 0
	buffer_store_dword v8, v7, s[24:27], s63 offen sc1
	s_mov_b64 exec, -1
	v_exp_f32 v54, v54
	v_exp_f32 v55, v55
	v_exp_f32 v56, v56
	v_exp_f32_e64 v57, v57
	v_mfma_f32_32x32x8_bf16 v[64:79], v[210:211], v[98:99], v[64:79]
	v_exp_f32 v58, v58
	v_exp_f32 v59, v59
	v_exp_f32 v60, v60
	v_exp_f32 v61, v61
	v_smfmac_f32_32x32x32_bf16 v[32:47], v[212:215], v[48:55], v87
	v_exp_f32 v62, v62
	v_exp_f32 v63, v63
	v_exp_f32 v64, v64
	v_exp_f32 v65, v65
	v_smfmac_f32_32x32x32_bf16 v[32:47], v[216:219], v[56:63], v87
	ds_read_b128 v[16:19], v1 offset:0
	v_exp_f32 v66, v66
	v_exp_f32 v67, v67
	v_exp_f32 v68, v68
	v_exp_f32 v69, v69
	v_mfma_f32_32x32x16_bf16 v[48:63], v[228:231], v[94:97], 0
	ds_read_b128 v[20:23], v1 offset:1024
	v_exp_f32 v70, v70
	v_exp_f32 v71, v71
	v_exp_f32 v72, v72
	v_exp_f32 v73, v73
	v_mfma_f32_32x32x8_bf16 v[48:63], v[236:237], v[98:99], v[48:63]
	ds_read_b128 v[24:27], v1 offset:2048
	v_exp_f32 v74, v74
	v_exp_f32 v75, v75
	v_exp_f32 v76, v76
	v_exp_f32 v77, v77
	v_smfmac_f32_32x32x32_bf16 v[32:47], v[220:223], v[64:71], v87
	v_exp_f32 v78, v78
	v_exp_f32 v79, v79
	v_exp_f32 v48, v48
	v_exp_f32 v49, v49
	v_smfmac_f32_32x32x32_bf16 v[32:47], v[224:227], v[72:79], v87
	ds_read_b128 v[88:91], v2
	v_exp_f32 v50, v50
	v_exp_f32 v51, v51
	v_exp_f32 v52, v52
	v_exp_f32 v53, v53
	v_mfma_f32_32x32x16_bf16 v[64:79], v[232:235], v[94:97], 0
	ds_read_b64 v[92:93], v3 offset:1024
	v_exp_f32 v54, v54
	v_exp_f32 v55, v55
	s_add_u32 m0, s59, 0
	v_exp_f32 v56, v56
	v_exp_f32_e64 v57, v57
	v_mfma_f32_32x32x8_bf16 v[64:79], v[238:239], v[98:99], v[64:79]
	buffer_load_dwordx4 v140, s[20:23], s58 offen lds
	v_exp_f32 v58, v58
	v_exp_f32 v59, v59
	s_add_u32 m0, s59, 1024
	v_exp_f32 v60, v60
	v_exp_f32 v61, v61
	v_smfmac_f32_32x32x32_bf16 v[32:47], v[240:243], v[48:55], v87
	buffer_load_dwordx4 v141, s[20:23], s58 offen lds
	v_exp_f32 v62, v62
	v_exp_f32 v63, v63
	v_exp_f32 v64, v64
	s_waitcnt lgkmcnt(0)
	v_exp_f32_e64 v65, v65
	v_smfmac_f32_32x32x32_bf16 v[32:47], v[244:247], v[56:63], v87
	v_exp_f32 v66, v66
	v_exp_f32 v67, v67
	s_add_u32 m0, s59, 2048
	v_exp_f32 v68, v68
	v_exp_f32 v69, v69
	v_mfma_f32_32x32x16_bf16 v[48:63], v[144:147], v[88:91], 0
	buffer_load_dwordx4 v142, s[20:23], s58 offen lds
	v_exp_f32 v70, v70
	v_exp_f32 v71, v71
	s_add_u32 m0, s59, 3072
	v_exp_f32 v72, v72
	v_exp_f32 v73, v73
	v_mfma_f32_32x32x8_bf16 v[48:63], v[152:153], v[92:93], v[48:63]
	buffer_load_dwordx4 v143, s[20:23], s58 offen lds
	v_exp_f32 v74, v74
	v_exp_f32 v75, v75
	s_add_u32 m0, s59, 4096
	v_exp_f32 v76, v76
	v_exp_f32 v77, v77
	v_smfmac_f32_32x32x32_bf16 v[32:47], v[248:251], v[64:71], v87
	buffer_load_dwordx4 v15, s[20:23], s58 offen lds
	s_add_u32 s58, s58, 327680
	v_exp_f32 v78, v78
	v_exp_f32 v79, v79
	v_exp_f32 v48, v48
	v_exp_f32 v49, v49
	v_smfmac_f32_32x32x32_bf16 v[32:47], v[252:255], v[72:79], v87
	v_exp_f32 v50, v50
	v_exp_f32 v51, v51
	v_exp_f32 v52, v52
	v_exp_f32 v53, v53
	v_mfma_f32_32x32x16_bf16 v[64:79], v[148:151], v[88:91], 0
	v_exp_f32 v54, v54
	v_exp_f32 v55, v55
	v_exp_f32 v56, v56
	v_exp_f32 v57, v57
	v_mfma_f32_32x32x8_bf16 v[64:79], v[154:155], v[92:93], v[64:79]
	v_exp_f32 v58, v58
	v_exp_f32 v59, v59
	v_exp_f32 v60, v60
	v_exp_f32 v61, v61
	v_smfmac_f32_32x32x32_bf16 v[16:31], v[156:159], v[48:55], v87
	v_exp_f32 v62, v62
	v_exp_f32 v63, v63
	v_exp_f32 v64, v64
	s_setprio 2
	v_exp_f32_e64 v65, v65
	v_smfmac_f32_32x32x32_bf16 v[16:31], v[160:163], v[56:63], v87
	ds_write_b128 v1, v[32:35] offset:0
	v_exp_f32 v66, v66
	v_exp_f32 v67, v67
	v_exp_f32 v68, v68
	v_exp_f32 v69, v69
	v_mfma_f32_32x32x16_bf16 v[48:63], v[172:175], v[88:91], 0
	ds_write_b128 v1, v[36:39] offset:1024
	v_exp_f32 v70, v70
	v_exp_f32 v71, v71
	v_exp_f32 v72, v72
	v_exp_f32 v73, v73
	v_mfma_f32_32x32x8_bf16 v[48:63], v[180:181], v[92:93], v[48:63]
	ds_write_b128 v1, v[40:43] offset:2048
	v_exp_f32 v74, v74
	v_exp_f32 v75, v75
	v_exp_f32 v76, v76
	v_exp_f32 v77, v77
	v_smfmac_f32_32x32x32_bf16 v[16:31], v[164:167], v[64:71], v87
	v_exp_f32 v78, v78
	v_exp_f32 v79, v79
	v_exp_f32 v48, v48
	v_exp_f32 v49, v49
	v_smfmac_f32_32x32x32_bf16 v[16:31], v[168:171], v[72:79], v87
	s_add_u32 s66, s16, 4
	s_and_b32 s66, s66, 7
	s_mul_i32 s66, s66, 3072
	s_add_u32 s66, s66, 122880
	v_add_u32 v1, s66, v14
	v_exp_f32 v50, v50
	v_exp_f32 v51, v51
	v_exp_f32 v52, v52
	v_exp_f32_e64 v53, v53
	v_mfma_f32_32x32x16_bf16 v[64:79], v[176:179], v[88:91], 0
	v_and_b32 v12, 7, v11
	v_min_u32 v12, 4, v12
	v_lshrrev_b32 v9, 3, v11
	s_nop 0
	v_mul_u32_u24 v9, 1280, v9
	v_lshl_add_u32 v12, v12, 7, v9
	s_and_b32 s66, s3, 7
	s_and_b32 s68, s17, 3
	s_lshl2_add_u32 s66, s66, s68
	s_mul_i32 s67, s16, 3840
	s_mul_i32 s68, s68, 160
	s_sub_u32 s67, s67, s68
	v_exp_f32 v54, v54
	v_exp_f32 v55, v55
	v_exp_f32 v56, v56
	v_exp_f32 v57, v57
	v_mfma_f32_32x32x8_bf16 v[64:79], v[182:183], v[92:93], v[64:79]
	s_mul_i32 s68, s66, 30720
	s_add_u32 s68, s68, s67
	s_add_u32 s68, s68, 983040
	s_mov_b64 exec, 0xffffff
	s_nop 0
	buffer_load_dword v9, v12, s[20:23], s68 offen
	s_mov_b64 exec, -1
	v_exp_f32 v58, v58
	v_exp_f32 v59, v59
	v_exp_f32 v60, v60
	s_setprio 1
	v_exp_f32 v61, v61
	v_smfmac_f32_32x32x32_bf16 v[16:31], v[184:187], v[48:55], v87
	s_mul_i32 s68, s66, 25600
	s_add_u32 s68, s68, s67
	s_mov_b64 exec, 0xffffff
	s_nop 0
	buffer_load_dword v10, v12, s[28:31], s68 offen
	s_mov_b64 exec, -1
	v_exp_f32 v62, v62
	v_exp_f32 v63, v63
	v_exp_f32 v64, v64
	v_exp_f32_e64 v65, v65
	v_smfmac_f32_32x32x32_bf16 v[16:31], v[188:191], v[56:63], v87
	s_add_u32 s66, s16, 3
	s_and_b32 s66, s66, 7
	s_mul_i32 s66, s66, 1536
	s_add_u32 s66, s66, 151040
	v_add_u32 v2, s66, v14
	v_add_u32 v3, s66, v4
	v_exp_f32 v66, v66
	v_exp_f32 v67, v67
	v_exp_f32 v68, v68
	v_exp_f32 v69, v69
	v_mfma_f32_32x32x16_bf16 v[48:63], v[200:203], v[88:91], 0
	v_exp_f32 v70, v70
	v_exp_f32 v71, v71
	v_exp_f32 v72, v72
	s_setprio 0
	v_exp_f32_e64 v73, v73
	v_mfma_f32_32x32x8_bf16 v[48:63], v[208:209], v[92:93], v[48:63]
	v_exp_f32 v74, v74
	v_exp_f32 v75, v75
	v_exp_f32 v76, v76
	v_exp_f32 v77, v77
	v_smfmac_f32_32x32x32_bf16 v[16:31], v[192:195], v[64:71], v87
	v_exp_f32 v78, v78
	v_exp_f32 v79, v79
	v_exp_f32 v48, v48
	s_waitcnt lgkmcnt(0)
	s_barrier
	v_exp_f32 v49, v49
	v_smfmac_f32_32x32x32_bf16 v[16:31], v[196:199], v[72:79], v87
	v_exp_f32 v50, v50
	s_setprio 3
	v_exp_f32 v51, v51
	v_exp_f32 v52, v52
	v_exp_f32_e64 v53, v53
	v_mfma_f32_32x32x16_bf16 v[64:79], v[204:207], v[88:91], 0
	v_exp_f32 v54, v54
	v_exp_f32 v55, v55
	v_exp_f32 v56, v56
	v_exp_f32 v57, v57
	v_mfma_f32_32x32x8_bf16 v[64:79], v[210:211], v[92:93], v[64:79]
	buffer_load_dword v8, v7, s[24:27], s61 offen sc1
	v_exp_f32 v58, v58
	v_exp_f32 v59, v59
	v_exp_f32 v60, v60
	v_exp_f32 v61, v61
	v_smfmac_f32_32x32x32_bf16 v[16:31], v[212:215], v[48:55], v87
	v_exp_f32 v62, v62
	v_exp_f32 v63, v63
	v_exp_f32 v64, v64
	v_exp_f32 v65, v65
	v_smfmac_f32_32x32x32_bf16 v[16:31], v[216:219], v[56:63], v87
	ds_read_b128 v[32:35], v1 offset:0
	v_exp_f32 v66, v66
	v_exp_f32 v67, v67
	v_exp_f32 v68, v68
	v_exp_f32 v69, v69
	v_mfma_f32_32x32x16_bf16 v[48:63], v[228:231], v[88:91], 0
	ds_read_b128 v[36:39], v1 offset:1024
	v_exp_f32 v70, v70
	v_exp_f32 v71, v71
	v_exp_f32 v72, v72
	v_exp_f32 v73, v73
	v_mfma_f32_32x32x8_bf16 v[48:63], v[236:237], v[92:93], v[48:63]
	ds_read_b128 v[40:43], v1 offset:2048
	v_exp_f32 v74, v74
	v_exp_f32 v75, v75
	v_exp_f32 v76, v76
	v_exp_f32 v77, v77
	v_smfmac_f32_32x32x32_bf16 v[16:31], v[220:223], v[64:71], v87
	v_exp_f32 v78, v78
	v_exp_f32 v79, v79
	v_exp_f32 v48, v48
	v_exp_f32 v49, v49
	v_smfmac_f32_32x32x32_bf16 v[16:31], v[224:227], v[72:79], v87
	ds_read_b128 v[94:97], v2
	v_exp_f32 v50, v50
	v_exp_f32 v51, v51
	v_exp_f32 v52, v52
	v_exp_f32 v53, v53
	v_mfma_f32_32x32x16_bf16 v[64:79], v[232:235], v[88:91], 0
	ds_read_b64 v[98:99], v3 offset:1024
	v_exp_f32 v54, v54
	v_exp_f32 v55, v55
	s_add_u32 m0, s59, 40960
	v_exp_f32 v56, v56
	v_exp_f32 v57, v57
	v_mfma_f32_32x32x8_bf16 v[64:79], v[238:239], v[92:93], v[64:79]
	buffer_load_dwordx4 v140, s[20:23], s58 offen lds
	v_exp_f32 v58, v58
	v_exp_f32 v59, v59
	s_add_u32 m0, s59, 41984
	v_exp_f32 v60, v60
	v_exp_f32 v61, v61
	v_smfmac_f32_32x32x32_bf16 v[16:31], v[240:243], v[48:55], v87
	buffer_load_dwordx4 v141, s[20:23], s58 offen lds
	v_exp_f32 v62, v62
	v_exp_f32 v63, v63
	v_exp_f32 v64, v64
	s_waitcnt lgkmcnt(0)
	v_exp_f32_e64 v65, v65
	v_smfmac_f32_32x32x32_bf16 v[16:31], v[244:247], v[56:63], v87
	v_exp_f32 v66, v66
	v_exp_f32 v67, v67
	s_add_u32 m0, s59, 43008
	v_exp_f32 v68, v68
	v_exp_f32 v69, v69
	v_mfma_f32_32x32x16_bf16 v[48:63], v[144:147], v[94:97], 0
	buffer_load_dwordx4 v142, s[20:23], s58 offen lds
	v_exp_f32 v70, v70
	v_exp_f32 v71, v71
	s_add_u32 m0, s59, 44032
	v_exp_f32 v72, v72
	v_exp_f32 v73, v73
	v_mfma_f32_32x32x8_bf16 v[48:63], v[152:153], v[98:99], v[48:63]
	buffer_load_dwordx4 v143, s[20:23], s58 offen lds
	v_exp_f32 v74, v74
	v_exp_f32 v75, v75
	s_add_u32 m0, s59, 45056
	v_exp_f32 v76, v76
	v_exp_f32 v77, v77
	v_smfmac_f32_32x32x32_bf16 v[16:31], v[248:251], v[64:71], v87
	buffer_load_dwordx4 v15, s[20:23], s58 offen lds
	s_add_u32 s58, s58, 327680
	v_exp_f32 v78, v78
	v_exp_f32 v79, v79
	v_exp_f32 v48, v48
	v_exp_f32 v49, v49
	v_smfmac_f32_32x32x32_bf16 v[16:31], v[252:255], v[72:79], v87
	v_exp_f32 v50, v50
	v_exp_f32 v51, v51
	v_exp_f32 v52, v52
	v_exp_f32 v53, v53
	v_mfma_f32_32x32x16_bf16 v[64:79], v[148:151], v[94:97], 0
	s_waitcnt vmcnt(5)
	s_nop 0
	v_cmp_ne_u32 s[66:67], 1, v8
	s_nop 1
	s_cmp_eq_u64 s[66:67], 0
	s_cbranch_scc0 SPIN_25
RET_26:
	v_exp_f32 v54, v54
	v_exp_f32_e64 v55, v55
	buffer_load_dwordx4 v[128:131], v5, s[24:27], s60 offen offset:0 sc1
	v_exp_f32 v56, v56
	v_exp_f32 v57, v57
	v_mfma_f32_32x32x8_bf16 v[64:79], v[154:155], v[98:99], v[64:79]
	buffer_load_dwordx4 v[132:135], v5, s[24:27], s60 offen offset:1024 sc1
	s_add_u32 s60, s60, 4096
	v_exp_f32 v58, v58
	v_exp_f32 v59, v59
	buffer_load_dwordx4 v[136:139], v5, s[24:27], s60 offen offset:0 sc1
	v_exp_f32 v60, v60
	v_exp_f32 v61, v61
	v_smfmac_f32_32x32x32_bf16 v[32:47], v[156:159], v[48:55], v87
	buffer_load_dwordx4 v[80:83], v5, s[24:27], s60 offen offset:1024 sc1
	s_add_u32 s60, s60, 4096
	v_exp_f32 v62, v62
	v_exp_f32 v63, v63
	v_exp_f32 v64, v64
	s_setprio 2
	v_exp_f32_e64 v65, v65
	v_smfmac_f32_32x32x32_bf16 v[32:47], v[160:163], v[56:63], v87
	ds_write_b128 v1, v[16:19] offset:0
	v_exp_f32 v66, v66
	v_exp_f32 v67, v67
	v_exp_f32 v68, v68
	v_exp_f32 v69, v69
	v_mfma_f32_32x32x16_bf16 v[48:63], v[172:175], v[94:97], 0
	ds_write_b128 v1, v[20:23] offset:1024
	v_exp_f32 v70, v70
	v_exp_f32 v71, v71
	v_exp_f32 v72, v72
	v_exp_f32 v73, v73
	v_mfma_f32_32x32x8_bf16 v[48:63], v[180:181], v[98:99], v[48:63]
	ds_write_b128 v1, v[24:27] offset:2048
	v_exp_f32 v74, v74
	v_exp_f32 v75, v75
	v_exp_f32 v76, v76
	v_exp_f32 v77, v77
	v_smfmac_f32_32x32x32_bf16 v[32:47], v[164:167], v[64:71], v87
	v_exp_f32 v78, v78
	v_exp_f32 v79, v79
	v_exp_f32 v48, v48
	v_exp_f32 v49, v49
	v_smfmac_f32_32x32x32_bf16 v[32:47], v[168:171], v[72:79], v87
	s_add_u32 s66, s16, 6
	s_and_b32 s66, s66, 7
	s_mul_i32 s66, s66, 3072
	s_add_u32 s66, s66, 122880
	v_add_u32 v1, s66, v14
	v_exp_f32 v50, v50
	v_exp_f32 v51, v51
	v_exp_f32 v52, v52
	v_exp_f32_e64 v53, v53
	v_mfma_f32_32x32x16_bf16 v[64:79], v[176:179], v[94:97], 0
	v_exp_f32 v54, v54
	v_exp_f32 v55, v55
	v_exp_f32 v56, v56
	v_exp_f32 v57, v57
	v_mfma_f32_32x32x8_bf16 v[64:79], v[182:183], v[98:99], v[64:79]
	v_exp_f32 v58, v58
	v_exp_f32 v59, v59
	v_exp_f32 v60, v60
	s_setprio 1
	v_exp_f32_e64 v61, v61
	v_smfmac_f32_32x32x32_bf16 v[32:47], v[184:187], v[48:55], v87
	v_exp_f32 v62, v62
	v_exp_f32 v63, v63
	v_exp_f32 v64, v64
	v_exp_f32 v65, v65
	v_smfmac_f32_32x32x32_bf16 v[32:47], v[188:191], v[56:63], v87
	s_add_u32 s66, s16, 4
	s_and_b32 s66, s66, 7
	s_mul_i32 s66, s66, 1536
	s_add_u32 s66, s66, 151040
	v_add_u32 v2, s66, v14
	v_add_u32 v3, s66, v4
	v_exp_f32 v66, v66
	v_exp_f32 v67, v67
	v_exp_f32 v68, v68
	v_exp_f32 v69, v69
	v_mfma_f32_32x32x16_bf16 v[48:63], v[200:203], v[94:97], 0
	v_exp_f32 v70, v70
	v_exp_f32 v71, v71
	v_exp_f32 v72, v72
	s_setprio 0
	v_exp_f32_e64 v73, v73
	v_mfma_f32_32x32x8_bf16 v[48:63], v[208:209], v[98:99], v[48:63]
	v_exp_f32 v74, v74
	v_exp_f32 v75, v75
	v_exp_f32 v76, v76
	v_exp_f32 v77, v77
	v_smfmac_f32_32x32x32_bf16 v[32:47], v[192:195], v[64:71], v87
	v_exp_f32 v78, v78
	v_exp_f32 v79, v79
	v_exp_f32 v48, v48
	s_waitcnt vmcnt(4) lgkmcnt(0)
	s_barrier
	v_exp_f32 v49, v49
	v_smfmac_f32_32x32x32_bf16 v[32:47], v[196:199], v[72:79], v87
	ds_read_b64_tr_b16 v[120:121], v0 offset:0
	ds_read_b64_tr_b16 v[122:123], v0 offset:2560
	v_exp_f32 v50, v50
	s_setprio 3
	v_exp_f32 v51, v51
	v_exp_f32 v52, v52
	v_exp_f32_e64 v53, v53
	v_mfma_f32_32x32x16_bf16 v[64:79], v[204:207], v[94:97], 0
	ds_read_b64_tr_b16 v[124:125], v0 offset:8
	ds_read_b64_tr_b16 v[126:127], v0 offset:2568
	v_exp_f32 v54, v54
	v_exp_f32 v55, v55
	v_exp_f32 v56, v56
	s_waitcnt vmcnt(3) lgkmcnt(2)
	v_mfma_f32_16x16x32_bf16 v[100:103], v[120:123], v[128:131], 0
	v_exp_f32_e64 v57, v57
	v_mfma_f32_32x32x8_bf16 v[64:79], v[210:211], v[98:99], v[64:79]
	ds_read_b64_tr_b16 v[120:121], v0 offset:16
	ds_read_b64_tr_b16 v[122:123], v0 offset:2576
	v_exp_f32 v58, v58
	v_exp_f32 v59, v59
	v_exp_f32 v60, v60
	s_waitcnt lgkmcnt(2)
	v_mfma_f32_16x16x32_bf16 v[104:107], v[124:127], v[128:131], 0
	v_exp_f32_e64 v61, v61
	v_smfmac_f32_32x32x32_bf16 v[32:47], v[212:215], v[48:55], v87
	ds_read_b64_tr_b16 v[124:125], v0 offset:24
	ds_read_b64_tr_b16 v[126:127], v0 offset:2584
	v_exp_f32 v62, v62
	v_exp_f32 v63, v63
	v_exp_f32 v64, v64
	s_waitcnt lgkmcnt(2)
	v_mfma_f32_16x16x32_bf16 v[108:111], v[120:123], v[128:131], 0
	v_exp_f32_e64 v65, v65
	v_smfmac_f32_32x32x32_bf16 v[32:47], v[216:219], v[56:63], v87
	ds_read_b128 v[16:19], v1 offset:0
	ds_read_b64_tr_b16 v[120:121], v0 offset:32
	ds_read_b64_tr_b16 v[122:123], v0 offset:2592
	v_exp_f32 v66, v66
	v_exp_f32 v67, v67
	v_exp_f32 v68, v68
	s_waitcnt lgkmcnt(3)
	v_mfma_f32_16x16x32_bf16 v[112:115], v[124:127], v[128:131], 0
	v_exp_f32_e64 v69, v69
	v_mfma_f32_32x32x16_bf16 v[48:63], v[228:231], v[94:97], 0
	ds_read_b128 v[20:23], v1 offset:1024
	ds_read_b64_tr_b16 v[124:125], v0 offset:5120
	ds_read_b64_tr_b16 v[126:127], v0 offset:7680
	v_exp_f32 v70, v70
	v_exp_f32 v71, v71
	v_exp_f32 v72, v72
	s_waitcnt lgkmcnt(3)
	v_mfma_f32_16x16x32_bf16 v[116:119], v[120:123], v[128:131], 0
	v_exp_f32_e64 v73, v73
	v_mfma_f32_32x32x8_bf16 v[48:63], v[236:237], v[98:99], v[48:63]
	ds_read_b128 v[24:27], v1 offset:2048
	ds_read_b64_tr_b16 v[120:121], v0 offset:5128
	ds_read_b64_tr_b16 v[122:123], v0 offset:7688
	v_exp_f32 v74, v74
	v_exp_f32 v75, v75
	buffer_load_dwordx4 v[128:131], v5, s[24:27], s60 offen offset:0 sc1
	v_exp_f32 v76, v76
	v_exp_f32 v77, v77
	v_smfmac_f32_32x32x32_bf16 v[32:47], v[220:223], v[64:71], v87
	v_exp_f32 v78, v78
	v_exp_f32 v79, v79
	v_exp_f32 v48, v48
	s_waitcnt vmcnt(3) lgkmcnt(3)
	v_mfma_f32_16x16x32_bf16 v[100:103], v[124:127], v[132:135], v[100:103]
	v_exp_f32_e64 v49, v49
	v_smfmac_f32_32x32x32_bf16 v[32:47], v[224:227], v[72:79], v87
	ds_read_b128 v[88:91], v2
	ds_read_b64_tr_b16 v[124:125], v0 offset:5136
	ds_read_b64_tr_b16 v[126:127], v0 offset:7696
	v_exp_f32 v50, v50
	v_exp_f32 v51, v51
	v_exp_f32 v52, v52
	s_waitcnt lgkmcnt(3)
	v_mfma_f32_16x16x32_bf16 v[104:107], v[120:123], v[132:135], v[104:107]
	v_exp_f32_e64 v53, v53
	v_mfma_f32_32x32x16_bf16 v[64:79], v[232:235], v[94:97], 0
	ds_read_b64 v[92:93], v3 offset:1024
	ds_read_b64_tr_b16 v[120:121], v0 offset:5144
	ds_read_b64_tr_b16 v[122:123], v0 offset:7704
	v_exp_f32 v54, v54
	v_exp_f32 v55, v55
	s_add_u32 m0, s59, 81920
	v_exp_f32 v56, v56
	s_waitcnt lgkmcnt(3)
	v_mfma_f32_16x16x32_bf16 v[108:111], v[124:127], v[132:135], v[108:111]
	v_exp_f32_e64 v57, v57
	v_mfma_f32_32x32x8_bf16 v[64:79], v[238:239], v[98:99], v[64:79]
	buffer_load_dwordx4 v140, s[20:23], s58 offen lds
	ds_read_b64_tr_b16 v[124:125], v0 offset:5152
	ds_read_b64_tr_b16 v[126:127], v0 offset:7712
	v_exp_f32 v58, v58
	v_exp_f32 v59, v59
	s_add_u32 m0, s59, 82944
	v_exp_f32 v60, v60
	v_exp_f32 v61, v61
	v_smfmac_f32_32x32x32_bf16 v[32:47], v[240:243], v[48:55], v87
	buffer_load_dwordx4 v141, s[20:23], s58 offen lds
	v_exp_f32 v62, v62
	v_exp_f32 v63, v63
	v_exp_f32 v64, v64
	s_waitcnt lgkmcnt(0)
	v_mfma_f32_16x16x32_bf16 v[112:115], v[120:123], v[132:135], v[112:115]
	v_exp_f32_e64 v65, v65
	v_smfmac_f32_32x32x32_bf16 v[32:47], v[244:247], v[56:63], v87
	ds_read_b64_tr_b16 v[120:121], v0 offset:20480
	ds_read_b64_tr_b16 v[122:123], v0 offset:23040
	v_exp_f32 v66, v66
	v_exp_f32 v67, v67
	s_add_u32 m0, s59, 83968
	v_exp_f32_e64 v68, v68
	v_mfma_f32_16x16x32_bf16 v[116:119], v[124:127], v[132:135], v[116:119]
	v_exp_f32_e64 v69, v69
	v_mfma_f32_32x32x16_bf16 v[48:63], v[144:147], v[88:91], 0
	buffer_load_dwordx4 v142, s[20:23], s58 offen lds
	ds_read_b64_tr_b16 v[124:125], v0 offset:20488
	ds_read_b64_tr_b16 v[126:127], v0 offset:23048
	v_exp_f32 v70, v70
	v_exp_f32 v71, v71
	s_add_u32 m0, s59, 84992
	buffer_load_dwordx4 v[132:135], v5, s[24:27], s60 offen offset:1024 sc1
	s_add_u32 s60, s60, 4096
	v_exp_f32 v72, v72
	s_waitcnt vmcnt(6) lgkmcnt(2)
	v_mfma_f32_16x16x32_bf16 v[100:103], v[120:123], v[136:139], v[100:103]
	v_exp_f32_e64 v73, v73
	v_mfma_f32_32x32x8_bf16 v[48:63], v[152:153], v[92:93], v[48:63]
	buffer_load_dwordx4 v143, s[20:23], s58 offen lds
	ds_read_b64_tr_b16 v[120:121], v0 offset:20496
	ds_read_b64_tr_b16 v[122:123], v0 offset:23056
	v_exp_f32 v74, v74
	v_exp_f32 v75, v75
	s_add_u32 m0, s59, 86016
	v_exp_f32 v76, v76
	s_waitcnt lgkmcnt(2)
	v_mfma_f32_16x16x32_bf16 v[104:107], v[124:127], v[136:139], v[104:107]
	v_exp_f32_e64 v77, v77
	v_smfmac_f32_32x32x32_bf16 v[32:47], v[248:251], v[64:71], v87
	buffer_load_dwordx4 v15, s[20:23], s58 offen lds
	s_add_u32 s58, s58, 327680
	ds_read_b64_tr_b16 v[124:125], v0 offset:20504
	ds_read_b64_tr_b16 v[126:127], v0 offset:23064
	v_exp_f32 v78, v78
	v_exp_f32 v79, v79
	v_exp_f32 v48, v48
	s_waitcnt lgkmcnt(2)
	v_mfma_f32_16x16x32_bf16 v[108:111], v[120:123], v[136:139], v[108:111]
	v_exp_f32_e64 v49, v49
	v_smfmac_f32_32x32x32_bf16 v[32:47], v[252:255], v[72:79], v87
	ds_read_b64_tr_b16 v[120:121], v0 offset:20512
	ds_read_b64_tr_b16 v[122:123], v0 offset:23072
	v_exp_f32 v50, v50
	v_exp_f32 v51, v51
	v_exp_f32 v52, v52
	s_waitcnt lgkmcnt(2)
	v_mfma_f32_16x16x32_bf16 v[112:115], v[124:127], v[136:139], v[112:115]
	v_exp_f32_e64 v53, v53
	v_mfma_f32_32x32x16_bf16 v[64:79], v[148:151], v[88:91], 0
	ds_read_b64_tr_b16 v[124:125], v0 offset:25600
	ds_read_b64_tr_b16 v[126:127], v0 offset:28160
	v_exp_f32 v54, v54
	v_exp_f32 v55, v55
	v_exp_f32 v56, v56
	s_waitcnt lgkmcnt(2)
	v_mfma_f32_16x16x32_bf16 v[116:119], v[120:123], v[136:139], v[116:119]
	v_exp_f32_e64 v57, v57
	v_mfma_f32_32x32x8_bf16 v[64:79], v[154:155], v[92:93], v[64:79]
	ds_read_b64_tr_b16 v[120:121], v0 offset:25608
	ds_read_b64_tr_b16 v[122:123], v0 offset:28168
	v_exp_f32 v58, v58
	v_exp_f32 v59, v59
	buffer_load_dwordx4 v[136:139], v5, s[24:27], s60 offen offset:0 sc1
	v_exp_f32 v60, v60
	v_exp_f32 v61, v61
	v_smfmac_f32_32x32x32_bf16 v[16:31], v[156:159], v[48:55], v87
	v_exp_f32 v62, v62
	v_exp_f32 v63, v63
	v_exp_f32_e64 v64, v64
	s_setprio 2
	s_waitcnt vmcnt(8) lgkmcnt(2)
	v_mfma_f32_16x16x32_bf16 v[100:103], v[124:127], v[80:83], v[100:103]
	v_exp_f32_e64 v65, v65
	v_smfmac_f32_32x32x32_bf16 v[16:31], v[160:163], v[56:63], v87
	ds_write_b128 v1, v[32:35] offset:0
	ds_read_b64_tr_b16 v[124:125], v0 offset:25616
	ds_read_b64_tr_b16 v[126:127], v0 offset:28176
	v_exp_f32 v66, v66
	v_exp_f32 v67, v67
	v_exp_f32 v68, v68
	s_waitcnt lgkmcnt(3)
	v_mfma_f32_16x16x32_bf16 v[104:107], v[120:123], v[80:83], v[104:107]
	v_exp_f32_e64 v69, v69
	v_mfma_f32_32x32x16_bf16 v[48:63], v[172:175], v[88:91], 0
	ds_write_b128 v1, v[36:39] offset:1024
	ds_read_b64_tr_b16 v[120:121], v0 offset:25624
	ds_read_b64_tr_b16 v[122:123], v0 offset:28184
	v_exp_f32 v70, v70
	v_exp_f32 v71, v71
	v_exp_f32 v72, v72
	s_waitcnt lgkmcnt(3)
	v_mfma_f32_16x16x32_bf16 v[108:111], v[124:127], v[80:83], v[108:111]
	v_exp_f32_e64 v73, v73
	v_mfma_f32_32x32x8_bf16 v[48:63], v[180:181], v[92:93], v[48:63]
	ds_write_b128 v1, v[40:43] offset:2048
	ds_read_b64_tr_b16 v[124:125], v0 offset:25632
	ds_read_b64_tr_b16 v[126:127], v0 offset:28192
	v_exp_f32 v74, v74
	v_exp_f32 v75, v75
	v_exp_f32 v76, v76
	v_exp_f32 v77, v77
	v_smfmac_f32_32x32x32_bf16 v[16:31], v[164:167], v[64:71], v87
	v_exp_f32 v78, v78
	v_exp_f32 v79, v79
	v_exp_f32 v48, v48
	s_waitcnt lgkmcnt(3)
	v_mfma_f32_16x16x32_bf16 v[112:115], v[120:123], v[80:83], v[112:115]
	v_exp_f32_e64 v49, v49
	v_smfmac_f32_32x32x32_bf16 v[16:31], v[168:171], v[72:79], v87
	s_add_u32 s66, s16, 8
	s_and_b32 s66, s66, 7
	s_mul_i32 s66, s66, 3072
	s_add_u32 s66, s66, 122880
	v_add_u32 v1, s66, v14
	s_nop 0
	ds_read_b64_tr_b16 v[120:121], v0 offset:40960
	ds_read_b64_tr_b16 v[122:123], v0 offset:43520
	v_exp_f32 v50, v50
	v_exp_f32 v51, v51
	v_exp_f32 v52, v52
	s_waitcnt lgkmcnt(2)
	v_mfma_f32_16x16x32_bf16 v[116:119], v[124:127], v[80:83], v[116:119]
	v_exp_f32_e64 v53, v53
	v_mfma_f32_32x32x16_bf16 v[64:79], v[176:179], v[88:91], 0
	ds_read_b64_tr_b16 v[124:125], v0 offset:40968
	ds_read_b64_tr_b16 v[126:127], v0 offset:43528
	v_exp_f32 v54, v54
	v_exp_f32 v55, v55
	buffer_load_dwordx4 v[80:83], v5, s[24:27], s60 offen offset:1024 sc1
	s_add_u32 s60, s60, 4096
	v_exp_f32 v56, v56
	s_waitcnt vmcnt(8) lgkmcnt(2)
	v_mfma_f32_16x16x32_bf16 v[100:103], v[120:123], v[128:131], v[100:103]
	v_exp_f32_e64 v57, v57
	v_mfma_f32_32x32x8_bf16 v[64:79], v[182:183], v[92:93], v[64:79]
	ds_read_b64_tr_b16 v[120:121], v0 offset:40976
	ds_read_b64_tr_b16 v[122:123], v0 offset:43536
	v_exp_f32 v58, v58
	v_exp_f32 v59, v59
	v_exp_f32_e64 v60, v60
	s_setprio 1
	s_waitcnt lgkmcnt(2)
	v_mfma_f32_16x16x32_bf16 v[104:107], v[124:127], v[128:131], v[104:107]
	v_exp_f32_e64 v61, v61
	v_smfmac_f32_32x32x32_bf16 v[16:31], v[184:187], v[48:55], v87
	ds_read_b64_tr_b16 v[124:125], v0 offset:40984
	ds_read_b64_tr_b16 v[126:127], v0 offset:43544
	v_exp_f32 v62, v62
	v_exp_f32 v63, v63
	v_exp_f32 v64, v64
	s_waitcnt lgkmcnt(2)
	v_mfma_f32_16x16x32_bf16 v[108:111], v[120:123], v[128:131], v[108:111]
	v_exp_f32_e64 v65, v65
	v_smfmac_f32_32x32x32_bf16 v[16:31], v[188:191], v[56:63], v87
	s_add_u32 s66, s16, 5
	s_and_b32 s66, s66, 7
	s_mul_i32 s66, s66, 1536
	s_add_u32 s66, s66, 151040
	v_add_u32 v2, s66, v14
	v_add_u32 v3, s66, v4
	ds_read_b64_tr_b16 v[120:121], v0 offset:40992
	ds_read_b64_tr_b16 v[122:123], v0 offset:43552
	v_exp_f32 v66, v66
	v_exp_f32 v67, v67
	v_exp_f32 v68, v68
	s_waitcnt lgkmcnt(2)
	v_mfma_f32_16x16x32_bf16 v[112:115], v[124:127], v[128:131], v[112:115]
	v_exp_f32_e64 v69, v69
	v_mfma_f32_32x32x16_bf16 v[48:63], v[200:203], v[88:91], 0
	ds_read_b64_tr_b16 v[124:125], v0 offset:46080
	ds_read_b64_tr_b16 v[126:127], v0 offset:48640
	v_exp_f32 v70, v70
	v_exp_f32 v71, v71
	v_exp_f32_e64 v72, v72
	s_setprio 0
	s_waitcnt lgkmcnt(2)
	v_mfma_f32_16x16x32_bf16 v[116:119], v[120:123], v[128:131], v[116:119]
	v_exp_f32_e64 v73, v73
	v_mfma_f32_32x32x8_bf16 v[48:63], v[208:209], v[92:93], v[48:63]
	ds_read_b64_tr_b16 v[120:121], v0 offset:46088
	ds_read_b64_tr_b16 v[122:123], v0 offset:48648
	v_exp_f32 v74, v74
	v_exp_f32 v75, v75
	buffer_load_dwordx4 v[128:131], v5, s[24:27], s60 offen offset:0 sc1
	v_exp_f32 v76, v76
	v_exp_f32 v77, v77
	v_smfmac_f32_32x32x32_bf16 v[16:31], v[192:195], v[64:71], v87
	v_exp_f32 v78, v78
	v_exp_f32 v79, v79
	v_exp_f32_e64 v48, v48
	s_waitcnt vmcnt(3) lgkmcnt(0)
	s_barrier
	v_mfma_f32_16x16x32_bf16 v[100:103], v[124:127], v[132:135], v[100:103]
	v_exp_f32_e64 v49, v49
	v_smfmac_f32_32x32x32_bf16 v[16:31], v[196:199], v[72:79], v87
	ds_read_b64_tr_b16 v[124:125], v0 offset:46096
	ds_read_b64_tr_b16 v[126:127], v0 offset:48656
	v_exp_f32 v50, v50
	s_setprio 3
	v_exp_f32 v51, v51
	v_exp_f32 v52, v52
	v_mfma_f32_16x16x32_bf16 v[104:107], v[120:123], v[132:135], v[104:107]
	v_exp_f32_e64 v53, v53
	v_mfma_f32_32x32x16_bf16 v[64:79], v[204:207], v[88:91], 0
	ds_read_b64_tr_b16 v[120:121], v0 offset:46104
	ds_read_b64_tr_b16 v[122:123], v0 offset:48664
	v_exp_f32 v54, v54
	v_exp_f32 v55, v55
	v_exp_f32 v56, v56
	s_waitcnt lgkmcnt(2)
	v_mfma_f32_16x16x32_bf16 v[108:111], v[124:127], v[132:135], v[108:111]
	v_exp_f32_e64 v57, v57
	v_mfma_f32_32x32x8_bf16 v[64:79], v[210:211], v[92:93], v[64:79]
	ds_read_b64_tr_b16 v[124:125], v0 offset:46112
	ds_read_b64_tr_b16 v[126:127], v0 offset:48672
	v_exp_f32 v58, v58
	v_exp_f32 v59, v59
	v_exp_f32 v60, v60
	v_exp_f32 v61, v61
	v_smfmac_f32_32x32x32_bf16 v[16:31], v[212:215], v[48:55], v87
	v_exp_f32 v62, v62
	v_exp_f32 v63, v63
	v_exp_f32 v64, v64
	s_waitcnt lgkmcnt(2)
	v_mfma_f32_16x16x32_bf16 v[112:115], v[120:123], v[132:135], v[112:115]
	v_exp_f32_e64 v65, v65
	v_smfmac_f32_32x32x32_bf16 v[16:31], v[216:219], v[56:63], v87
	ds_read_b128 v[32:35], v1 offset:0
	v_add_u32 v0, 61440, v0
	ds_read_b64_tr_b16 v[120:121], v0 offset:0
	ds_read_b64_tr_b16 v[122:123], v0 offset:2560
	v_exp_f32 v66, v66
	v_exp_f32 v67, v67
	v_exp_f32 v68, v68
	s_waitcnt lgkmcnt(3)
	v_mfma_f32_16x16x32_bf16 v[116:119], v[124:127], v[132:135], v[116:119]
	v_exp_f32_e64 v69, v69
	v_mfma_f32_32x32x16_bf16 v[48:63], v[228:231], v[88:91], 0
	ds_read_b128 v[36:39], v1 offset:1024
	ds_read_b64_tr_b16 v[124:125], v0 offset:8
	ds_read_b64_tr_b16 v[126:127], v0 offset:2568
	v_exp_f32 v70, v70
	v_exp_f32 v71, v71
	buffer_load_dwordx4 v[132:135], v5, s[24:27], s60 offen offset:1024 sc1
	s_add_u32 s60, s60, 4096
	v_exp_f32 v72, v72
	s_waitcnt vmcnt(3) lgkmcnt(3)
	v_mfma_f32_16x16x32_bf16 v[100:103], v[120:123], v[136:139], v[100:103]
	v_exp_f32_e64 v73, v73
	v_mfma_f32_32x32x8_bf16 v[48:63], v[236:237], v[92:93], v[48:63]
	ds_read_b128 v[40:43], v1 offset:2048
	ds_read_b64_tr_b16 v[120:121], v0 offset:16
	ds_read_b64_tr_b16 v[122:123], v0 offset:2576
	v_exp_f32 v74, v74
	v_exp_f32 v75, v75
	v_exp_f32 v76, v76
	s_waitcnt lgkmcnt(3)
	v_mfma_f32_16x16x32_bf16 v[104:107], v[124:127], v[136:139], v[104:107]
	v_exp_f32_e64 v77, v77
	v_smfmac_f32_32x32x32_bf16 v[16:31], v[220:223], v[64:71], v87
	ds_read_b64_tr_b16 v[124:125], v0 offset:24
	ds_read_b64_tr_b16 v[126:127], v0 offset:2584
	v_exp_f32 v78, v78
	v_exp_f32 v79, v79
	v_exp_f32 v48, v48
	s_waitcnt lgkmcnt(2)
	v_mfma_f32_16x16x32_bf16 v[108:111], v[120:123], v[136:139], v[108:111]
	v_exp_f32_e64 v49, v49
	v_smfmac_f32_32x32x32_bf16 v[16:31], v[224:227], v[72:79], v87
	ds_read_b128 v[94:97], v2
	ds_read_b64_tr_b16 v[120:121], v0 offset:32
	ds_read_b64_tr_b16 v[122:123], v0 offset:2592
	v_exp_f32 v50, v50
	v_exp_f32 v51, v51
	v_exp_f32 v52, v52
	s_waitcnt lgkmcnt(3)
	v_mfma_f32_16x16x32_bf16 v[112:115], v[124:127], v[136:139], v[112:115]
	v_exp_f32_e64 v53, v53
	v_mfma_f32_32x32x16_bf16 v[64:79], v[232:235], v[88:91], 0
	ds_read_b64 v[98:99], v3 offset:1024
	ds_read_b64_tr_b16 v[124:125], v0 offset:5120
	ds_read_b64_tr_b16 v[126:127], v0 offset:7680
	v_exp_f32 v54, v54
	v_exp_f32 v55, v55
	s_add_u32 m0, s59, 0
	v_exp_f32_e64 v56, v56
	s_waitcnt lgkmcnt(3)
	v_mfma_f32_16x16x32_bf16 v[116:119], v[120:123], v[136:139], v[116:119]
	v_exp_f32_e64 v57, v57
	v_mfma_f32_32x32x8_bf16 v[64:79], v[238:239], v[92:93], v[64:79]
	buffer_load_dwordx4 v140, s[20:23], s58 offen lds
	ds_read_b64_tr_b16 v[120:121], v0 offset:5128
	ds_read_b64_tr_b16 v[122:123], v0 offset:7688
	v_exp_f32 v58, v58
	v_exp_f32 v59, v59
	s_add_u32 m0, s59, 1024
	buffer_load_dwordx4 v[136:139], v5, s[24:27], s60 offen offset:0 sc1
	v_exp_f32 v60, v60
	v_exp_f32 v61, v61
	v_smfmac_f32_32x32x32_bf16 v[16:31], v[240:243], v[48:55], v87
	buffer_load_dwordx4 v141, s[20:23], s58 offen lds
	v_exp_f32 v62, v62
	v_exp_f32 v63, v63
	v_exp_f32_e64 v64, v64
	s_waitcnt lgkmcnt(0)
	s_waitcnt vmcnt(5)
	v_mfma_f32_16x16x32_bf16 v[100:103], v[124:127], v[80:83], v[100:103]
	v_exp_f32_e64 v65, v65
	v_smfmac_f32_32x32x32_bf16 v[16:31], v[244:247], v[56:63], v87
	ds_read_b64_tr_b16 v[124:125], v0 offset:5136
	ds_read_b64_tr_b16 v[126:127], v0 offset:7696
	v_exp_f32 v66, v66
	v_exp_f32 v67, v67
	s_add_u32 m0, s59, 2048
	v_exp_f32_e64 v68, v68
	v_mfma_f32_16x16x32_bf16 v[104:107], v[120:123], v[80:83], v[104:107]
	v_exp_f32_e64 v69, v69
	v_mfma_f32_32x32x16_bf16 v[48:63], v[144:147], v[94:97], 0
	buffer_load_dwordx4 v142, s[20:23], s58 offen lds
	ds_read_b64_tr_b16 v[120:121], v0 offset:5144
	ds_read_b64_tr_b16 v[122:123], v0 offset:7704
	v_exp_f32 v70, v70
	v_exp_f32 v71, v71
	s_add_u32 m0, s59, 3072
	v_exp_f32 v72, v72
	s_waitcnt lgkmcnt(2)
	v_mfma_f32_16x16x32_bf16 v[108:111], v[124:127], v[80:83], v[108:111]
	v_exp_f32_e64 v73, v73
	v_mfma_f32_32x32x8_bf16 v[48:63], v[152:153], v[98:99], v[48:63]
	buffer_load_dwordx4 v143, s[20:23], s58 offen lds
	ds_read_b64_tr_b16 v[124:125], v0 offset:5152
	ds_read_b64_tr_b16 v[126:127], v0 offset:7712
	v_exp_f32 v74, v74
	v_exp_f32 v75, v75
	s_add_u32 m0, s59, 4096
	v_exp_f32 v76, v76
	v_exp_f32 v77, v77
	v_smfmac_f32_32x32x32_bf16 v[16:31], v[248:251], v[64:71], v87
	buffer_load_dwordx4 v15, s[20:23], s58 offen lds
	s_add_u32 s58, s58, 327680
	v_exp_f32 v78, v78
	v_exp_f32 v79, v79
	v_exp_f32 v48, v48
	s_waitcnt lgkmcnt(2)
	v_mfma_f32_16x16x32_bf16 v[112:115], v[120:123], v[80:83], v[112:115]
	v_exp_f32_e64 v49, v49
	v_smfmac_f32_32x32x32_bf16 v[16:31], v[252:255], v[72:79], v87
	ds_read_b64_tr_b16 v[120:121], v0 offset:20480
	ds_read_b64_tr_b16 v[122:123], v0 offset:23040
	v_exp_f32 v50, v50
	v_exp_f32 v51, v51
	v_exp_f32 v52, v52
	s_waitcnt lgkmcnt(2)
	v_mfma_f32_16x16x32_bf16 v[116:119], v[124:127], v[80:83], v[116:119]
	v_exp_f32_e64 v53, v53
	v_mfma_f32_32x32x16_bf16 v[64:79], v[148:151], v[94:97], 0
	ds_read_b64_tr_b16 v[124:125], v0 offset:20488
	ds_read_b64_tr_b16 v[126:127], v0 offset:23048
	v_exp_f32 v54, v54
	v_exp_f32 v55, v55
	buffer_load_dwordx4 v[80:83], v5, s[24:27], s60 offen offset:1024 sc1
	s_add_u32 s60, s60, 4096
	v_exp_f32 v56, v56
	s_waitcnt vmcnt(8) lgkmcnt(2)
	v_mfma_f32_16x16x32_bf16 v[100:103], v[120:123], v[128:131], v[100:103]
	v_exp_f32_e64 v57, v57
	v_mfma_f32_32x32x8_bf16 v[64:79], v[154:155], v[98:99], v[64:79]
	ds_read_b64_tr_b16 v[120:121], v0 offset:20496
	ds_read_b64_tr_b16 v[122:123], v0 offset:23056
	v_exp_f32 v58, v58
	v_exp_f32 v59, v59
	v_exp_f32 v60, v60
	s_waitcnt lgkmcnt(2)
	v_mfma_f32_16x16x32_bf16 v[104:107], v[124:127], v[128:131], v[104:107]
	v_exp_f32_e64 v61, v61
	v_smfmac_f32_32x32x32_bf16 v[32:47], v[156:159], v[48:55], v87
	ds_read_b64_tr_b16 v[124:125], v0 offset:20504
	ds_read_b64_tr_b16 v[126:127], v0 offset:23064
	v_exp_f32 v62, v62
	v_exp_f32 v63, v63
	v_exp_f32_e64 v64, v64
	s_setprio 2
	s_waitcnt lgkmcnt(2)
	v_mfma_f32_16x16x32_bf16 v[108:111], v[120:123], v[128:131], v[108:111]
	v_exp_f32_e64 v65, v65
	v_smfmac_f32_32x32x32_bf16 v[32:47], v[160:163], v[56:63], v87
	ds_write_b128 v1, v[16:19] offset:0
	ds_read_b64_tr_b16 v[120:121], v0 offset:20512
	ds_read_b64_tr_b16 v[122:123], v0 offset:23072
	v_exp_f32 v66, v66
	v_exp_f32 v67, v67
	v_exp_f32 v68, v68
	s_waitcnt lgkmcnt(3)
	v_mfma_f32_16x16x32_bf16 v[112:115], v[124:127], v[128:131], v[112:115]
	v_exp_f32_e64 v69, v69
	v_mfma_f32_32x32x16_bf16 v[48:63], v[172:175], v[94:97], 0
	ds_write_b128 v1, v[20:23] offset:1024
	ds_read_b64_tr_b16 v[124:125], v0 offset:25600
	ds_read_b64_tr_b16 v[126:127], v0 offset:28160
	v_exp_f32 v70, v70
	v_exp_f32 v71, v71
	v_exp_f32 v72, v72
	s_waitcnt lgkmcnt(3)
	v_mfma_f32_16x16x32_bf16 v[116:119], v[120:123], v[128:131], v[116:119]
	v_exp_f32_e64 v73, v73
	v_mfma_f32_32x32x8_bf16 v[48:63], v[180:181], v[98:99], v[48:63]
	ds_write_b128 v1, v[24:27] offset:2048
	ds_read_b64_tr_b16 v[120:121], v0 offset:25608
	ds_read_b64_tr_b16 v[122:123], v0 offset:28168
	v_exp_f32 v74, v74
	v_exp_f32 v75, v75
	buffer_load_dwordx4 v[128:131], v5, s[24:27], s60 offen offset:0 sc1
	v_exp_f32 v76, v76
	v_exp_f32 v77, v77
	v_smfmac_f32_32x32x32_bf16 v[32:47], v[164:167], v[64:71], v87
	v_exp_f32 v78, v78
	v_exp_f32 v79, v79
	v_exp_f32 v48, v48
	s_waitcnt vmcnt(8) lgkmcnt(3)
	v_mfma_f32_16x16x32_bf16 v[100:103], v[124:127], v[132:135], v[100:103]
	v_exp_f32_e64 v49, v49
	v_smfmac_f32_32x32x32_bf16 v[32:47], v[168:171], v[72:79], v87
	s_add_u32 s66, s16, 10
	s_and_b32 s66, s66, 7
	s_mul_i32 s66, s66, 3072
	s_add_u32 s66, s66, 122880
	v_add_u32 v1, s66, v14
	s_nop 0
	ds_read_b64_tr_b16 v[124:125], v0 offset:25616
	ds_read_b64_tr_b16 v[126:127], v0 offset:28176
	v_exp_f32 v50, v50
	v_exp_f32 v51, v51
	v_exp_f32 v52, v52
	s_waitcnt lgkmcnt(2)
	v_mfma_f32_16x16x32_bf16 v[104:107], v[120:123], v[132:135], v[104:107]
	v_exp_f32_e64 v53, v53
	v_mfma_f32_32x32x16_bf16 v[64:79], v[176:179], v[94:97], 0
	ds_read_b64_tr_b16 v[120:121], v0 offset:25624
	ds_read_b64_tr_b16 v[122:123], v0 offset:28184
	v_exp_f32 v54, v54
	v_exp_f32 v55, v55
	v_exp_f32 v56, v56
	s_waitcnt lgkmcnt(2)
	v_mfma_f32_16x16x32_bf16 v[108:111], v[124:127], v[132:135], v[108:111]
	v_exp_f32_e64 v57, v57
	v_mfma_f32_32x32x8_bf16 v[64:79], v[182:183], v[98:99], v[64:79]
	ds_read_b64_tr_b16 v[124:125], v0 offset:25632
	ds_read_b64_tr_b16 v[126:127], v0 offset:28192
	v_exp_f32 v58, v58
	v_exp_f32 v59, v59
	v_exp_f32 v60, v60
	s_setprio 1
	v_exp_f32_e64 v61, v61
	v_smfmac_f32_32x32x32_bf16 v[32:47], v[184:187], v[48:55], v87
	v_exp_f32 v62, v62
	v_exp_f32 v63, v63
	v_exp_f32 v64, v64
	s_waitcnt lgkmcnt(2)
	v_mfma_f32_16x16x32_bf16 v[112:115], v[120:123], v[132:135], v[112:115]
	v_exp_f32_e64 v65, v65
	v_smfmac_f32_32x32x32_bf16 v[32:47], v[188:191], v[56:63], v87
	s_add_u32 s66, s16, 6
	s_and_b32 s66, s66, 7
	s_mul_i32 s66, s66, 1536
	s_add_u32 s66, s66, 151040
	v_add_u32 v2, s66, v14
	v_add_u32 v3, s66, v4
	ds_read_b64_tr_b16 v[120:121], v0 offset:40960
	ds_read_b64_tr_b16 v[122:123], v0 offset:43520
	v_exp_f32 v66, v66
	v_exp_f32 v67, v67
	v_exp_f32 v68, v68
	s_waitcnt lgkmcnt(2)
	v_mfma_f32_16x16x32_bf16 v[116:119], v[124:127], v[132:135], v[116:119]
	v_exp_f32_e64 v69, v69
	v_mfma_f32_32x32x16_bf16 v[48:63], v[200:203], v[94:97], 0
	ds_read_b64_tr_b16 v[124:125], v0 offset:40968
	ds_read_b64_tr_b16 v[126:127], v0 offset:43528
	v_exp_f32 v70, v70
	v_exp_f32 v71, v71
	buffer_load_dwordx4 v[132:135], v5, s[24:27], s60 offen offset:1024 sc1
	s_add_u32 s60, s60, 4096
	v_exp_f32_e64 v72, v72
	s_setprio 0
	s_waitcnt vmcnt(7) lgkmcnt(2)
	v_mfma_f32_16x16x32_bf16 v[100:103], v[120:123], v[136:139], v[100:103]
	v_exp_f32_e64 v73, v73
	v_mfma_f32_32x32x8_bf16 v[48:63], v[208:209], v[98:99], v[48:63]
	ds_read_b64_tr_b16 v[120:121], v0 offset:40976
	ds_read_b64_tr_b16 v[122:123], v0 offset:43536
	v_exp_f32 v74, v74
	v_exp_f32 v75, v75
	v_exp_f32 v76, v76
	s_waitcnt lgkmcnt(2)
	v_mfma_f32_16x16x32_bf16 v[104:107], v[124:127], v[136:139], v[104:107]
	v_exp_f32_e64 v77, v77
	v_smfmac_f32_32x32x32_bf16 v[32:47], v[192:195], v[64:71], v87
	ds_read_b64_tr_b16 v[124:125], v0 offset:40984
	ds_read_b64_tr_b16 v[126:127], v0 offset:43544
	v_exp_f32 v78, v78
	v_exp_f32 v79, v79
	v_exp_f32_e64 v48, v48
	s_waitcnt vmcnt(3) lgkmcnt(0)
	s_barrier
	v_mfma_f32_16x16x32_bf16 v[108:111], v[120:123], v[136:139], v[108:111]
	v_exp_f32_e64 v49, v49
	v_smfmac_f32_32x32x32_bf16 v[32:47], v[196:199], v[72:79], v87
	ds_read_b64_tr_b16 v[120:121], v0 offset:40992
	ds_read_b64_tr_b16 v[122:123], v0 offset:43552
	v_exp_f32 v50, v50
	s_setprio 3
	v_exp_f32 v51, v51
	v_exp_f32 v52, v52
	v_mfma_f32_16x16x32_bf16 v[112:115], v[124:127], v[136:139], v[112:115]
	v_exp_f32_e64 v53, v53
	v_mfma_f32_32x32x16_bf16 v[64:79], v[204:207], v[94:97], 0
	ds_read_b64_tr_b16 v[124:125], v0 offset:46080
	ds_read_b64_tr_b16 v[126:127], v0 offset:48640
	v_exp_f32 v54, v54
	v_exp_f32 v55, v55
	v_exp_f32 v56, v56
	s_waitcnt lgkmcnt(2)
	v_mfma_f32_16x16x32_bf16 v[116:119], v[120:123], v[136:139], v[116:119]
	v_exp_f32_e64 v57, v57
	v_mfma_f32_32x32x8_bf16 v[64:79], v[210:211], v[98:99], v[64:79]
	ds_read_b64_tr_b16 v[120:121], v0 offset:46088
	ds_read_b64_tr_b16 v[122:123], v0 offset:48648
	v_exp_f32 v58, v58
	v_exp_f32 v59, v59
	buffer_load_dwordx4 v[136:139], v5, s[24:27], s60 offen offset:0 sc1
	v_exp_f32 v60, v60
	v_exp_f32 v61, v61
	v_smfmac_f32_32x32x32_bf16 v[32:47], v[212:215], v[48:55], v87
	v_exp_f32 v62, v62
	v_exp_f32 v63, v63
	v_exp_f32 v64, v64
	s_waitcnt vmcnt(3) lgkmcnt(2)
	v_mfma_f32_16x16x32_bf16 v[100:103], v[124:127], v[80:83], v[100:103]
	v_exp_f32_e64 v65, v65
	v_smfmac_f32_32x32x32_bf16 v[32:47], v[216:219], v[56:63], v87
	ds_read_b128 v[16:19], v1 offset:0
	ds_read_b64_tr_b16 v[124:125], v0 offset:46096
	ds_read_b64_tr_b16 v[126:127], v0 offset:48656
	v_exp_f32 v66, v66
	v_exp_f32 v67, v67
	v_exp_f32 v68, v68
	s_waitcnt lgkmcnt(3)
	v_mfma_f32_16x16x32_bf16 v[104:107], v[120:123], v[80:83], v[104:107]
	v_exp_f32_e64 v69, v69
	v_mfma_f32_32x32x16_bf16 v[48:63], v[228:231], v[94:97], 0
	ds_read_b128 v[20:23], v1 offset:1024
	ds_read_b64_tr_b16 v[120:121], v0 offset:46104
	ds_read_b64_tr_b16 v[122:123], v0 offset:48664
	v_exp_f32 v70, v70
	v_exp_f32 v71, v71
	v_exp_f32 v72, v72
	s_waitcnt lgkmcnt(3)
	v_mfma_f32_16x16x32_bf16 v[108:111], v[124:127], v[80:83], v[108:111]
	v_exp_f32_e64 v73, v73
	v_mfma_f32_32x32x8_bf16 v[48:63], v[236:237], v[98:99], v[48:63]
	ds_read_b128 v[24:27], v1 offset:2048
	ds_read_b64_tr_b16 v[124:125], v0 offset:46112
	ds_read_b64_tr_b16 v[126:127], v0 offset:48672
	v_exp_f32 v74, v74
	v_exp_f32 v75, v75
	v_exp_f32 v76, v76
	v_exp_f32 v77, v77
	v_smfmac_f32_32x32x32_bf16 v[32:47], v[220:223], v[64:71], v87
	v_exp_f32 v78, v78
	v_exp_f32 v79, v79
	v_exp_f32 v48, v48
	s_waitcnt lgkmcnt(3)
	v_mfma_f32_16x16x32_bf16 v[112:115], v[120:123], v[80:83], v[112:115]
	v_exp_f32_e64 v49, v49
	v_smfmac_f32_32x32x32_bf16 v[32:47], v[224:227], v[72:79], v87
	ds_read_b128 v[88:91], v2
	v_add_u32 v0, 4294905856, v0
	ds_read_b64_tr_b16 v[120:121], v0 offset:0
	ds_read_b64_tr_b16 v[122:123], v0 offset:2560
	v_exp_f32 v50, v50
	v_exp_f32 v51, v51
	v_exp_f32 v52, v52
	s_waitcnt lgkmcnt(3)
	v_mfma_f32_16x16x32_bf16 v[116:119], v[124:127], v[80:83], v[116:119]
	v_exp_f32_e64 v53, v53
	v_mfma_f32_32x32x16_bf16 v[64:79], v[232:235], v[94:97], 0
	ds_read_b64 v[92:93], v3 offset:1024
	ds_read_b64_tr_b16 v[124:125], v0 offset:8
	ds_read_b64_tr_b16 v[126:127], v0 offset:2568
	v_exp_f32 v54, v54
	v_exp_f32 v55, v55
	s_add_u32 m0, s59, 40960
	buffer_load_dwordx4 v[80:83], v5, s[24:27], s60 offen offset:1024 sc1
	s_add_u32 s60, s60, 4096
	s_and_b32 s66, s19, 1
	s_lshl_b32 s66, s66, 10
	s_add_u32 s60, s60, s66
	v_exp_f32_e64 v56, v56
	s_waitcnt vmcnt(3) lgkmcnt(3)
	v_mfma_f32_16x16x32_bf16 v[100:103], v[120:123], v[128:131], v[100:103]
	v_exp_f32_e64 v57, v57
	v_mfma_f32_32x32x8_bf16 v[64:79], v[238:239], v[98:99], v[64:79]
	buffer_load_dwordx4 v140, s[20:23], s58 offen lds
	ds_read_b64_tr_b16 v[120:121], v0 offset:16
	ds_read_b64_tr_b16 v[122:123], v0 offset:2576
	v_exp_f32 v58, v58
	v_exp_f32 v59, v59
	s_add_u32 m0, s59, 41984
	v_exp_f32 v60, v60
	s_waitcnt lgkmcnt(2)
	v_mfma_f32_16x16x32_bf16 v[104:107], v[124:127], v[128:131], v[104:107]
	v_exp_f32_e64 v61, v61
	v_smfmac_f32_32x32x32_bf16 v[32:47], v[240:243], v[48:55], v87
	buffer_load_dwordx4 v141, s[20:23], s58 offen lds
	ds_read_b64_tr_b16 v[124:125], v0 offset:24
	ds_read_b64_tr_b16 v[126:127], v0 offset:2584
	v_exp_f32 v62, v62
	v_exp_f32 v63, v63
	v_exp_f32 v64, v64
	s_waitcnt lgkmcnt(0)
	v_mfma_f32_16x16x32_bf16 v[108:111], v[120:123], v[128:131], v[108:111]
	v_exp_f32_e64 v65, v65
	v_smfmac_f32_32x32x32_bf16 v[32:47], v[244:247], v[56:63], v87
	ds_read_b64_tr_b16 v[120:121], v0 offset:32
	ds_read_b64_tr_b16 v[122:123], v0 offset:2592
	v_exp_f32 v66, v66
	v_exp_f32 v67, v67
	s_add_u32 m0, s59, 43008
	v_exp_f32_e64 v68, v68
	v_mfma_f32_16x16x32_bf16 v[112:115], v[124:127], v[128:131], v[112:115]
	v_exp_f32_e64 v69, v69
	v_mfma_f32_32x32x16_bf16 v[48:63], v[144:147], v[88:91], 0
	buffer_load_dwordx4 v142, s[20:23], s58 offen lds
	ds_read_b64_tr_b16 v[124:125], v0 offset:5120
	ds_read_b64_tr_b16 v[126:127], v0 offset:7680
	v_exp_f32 v70, v70
	v_exp_f32 v71, v71
	s_add_u32 m0, s59, 44032
	v_exp_f32 v72, v72
	s_waitcnt lgkmcnt(2)
	v_mfma_f32_16x16x32_bf16 v[116:119], v[120:123], v[128:131], v[116:119]
	v_exp_f32_e64 v73, v73
	v_mfma_f32_32x32x8_bf16 v[48:63], v[152:153], v[92:93], v[48:63]
	buffer_load_dwordx4 v143, s[20:23], s58 offen lds
	ds_read_b64_tr_b16 v[120:121], v0 offset:5128
	ds_read_b64_tr_b16 v[122:123], v0 offset:7688
	v_exp_f32 v74, v74
	v_exp_f32 v75, v75
	s_add_u32 m0, s59, 45056
	v_exp_f32 v76, v76
	v_exp_f32 v77, v77
	v_smfmac_f32_32x32x32_bf16 v[32:47], v[248:251], v[64:71], v87
	buffer_load_dwordx4 v15, s[20:23], s58 offen lds
	s_add_u32 s58, s58, 327680
	v_exp_f32 v78, v78
	v_exp_f32 v79, v79
	v_exp_f32 v48, v48
	s_waitcnt vmcnt(7) lgkmcnt(2)
	v_mfma_f32_16x16x32_bf16 v[100:103], v[124:127], v[132:135], v[100:103]
	v_exp_f32_e64 v49, v49
	v_smfmac_f32_32x32x32_bf16 v[32:47], v[252:255], v[72:79], v87
	ds_read_b64_tr_b16 v[124:125], v0 offset:5136
	ds_read_b64_tr_b16 v[126:127], v0 offset:7696
	v_exp_f32 v50, v50
	v_exp_f32 v51, v51
	v_exp_f32 v52, v52
	s_waitcnt lgkmcnt(2)
	v_mfma_f32_16x16x32_bf16 v[104:107], v[120:123], v[132:135], v[104:107]
	v_exp_f32_e64 v53, v53
	v_mfma_f32_32x32x16_bf16 v[64:79], v[148:151], v[88:91], 0
	ds_read_b64_tr_b16 v[120:121], v0 offset:5144
	ds_read_b64_tr_b16 v[122:123], v0 offset:7704
	v_exp_f32 v54, v54
	v_exp_f32 v55, v55
	v_exp_f32 v56, v56
	s_waitcnt lgkmcnt(2)
	v_mfma_f32_16x16x32_bf16 v[108:111], v[124:127], v[132:135], v[108:111]
	v_exp_f32_e64 v57, v57
	v_mfma_f32_32x32x8_bf16 v[64:79], v[154:155], v[92:93], v[64:79]
	ds_read_b64_tr_b16 v[124:125], v0 offset:5152
	ds_read_b64_tr_b16 v[126:127], v0 offset:7712
	v_exp_f32 v58, v58
	v_exp_f32 v59, v59
	v_exp_f32 v60, v60
	v_exp_f32 v61, v61
	v_smfmac_f32_32x32x32_bf16 v[16:31], v[156:159], v[48:55], v87
	v_exp_f32 v62, v62
	v_exp_f32 v63, v63
	v_exp_f32_e64 v64, v64
	s_setprio 2
	s_waitcnt lgkmcnt(2)
	v_mfma_f32_16x16x32_bf16 v[112:115], v[120:123], v[132:135], v[112:115]
	v_exp_f32_e64 v65, v65
	v_smfmac_f32_32x32x32_bf16 v[16:31], v[160:163], v[56:63], v87
	ds_write_b128 v1, v[32:35] offset:0
	ds_read_b64_tr_b16 v[120:121], v0 offset:20480
	ds_read_b64_tr_b16 v[122:123], v0 offset:23040
	v_exp_f32 v66, v66
	v_exp_f32 v67, v67
	v_exp_f32 v68, v68
	s_waitcnt lgkmcnt(3)
	v_mfma_f32_16x16x32_bf16 v[116:119], v[124:127], v[132:135], v[116:119]
	v_exp_f32_e64 v69, v69
	v_mfma_f32_32x32x16_bf16 v[48:63], v[172:175], v[88:91], 0
	ds_write_b128 v1, v[36:39] offset:1024
	ds_read_b64_tr_b16 v[124:125], v0 offset:20488
	ds_read_b64_tr_b16 v[126:127], v0 offset:23048
	v_exp_f32 v70, v70
	v_exp_f32 v71, v71
	v_exp_f32 v72, v72
	s_waitcnt vmcnt(6) lgkmcnt(3)
	v_mfma_f32_16x16x32_bf16 v[100:103], v[120:123], v[136:139], v[100:103]
	v_exp_f32_e64 v73, v73
	v_mfma_f32_32x32x8_bf16 v[48:63], v[180:181], v[92:93], v[48:63]
	ds_write_b128 v1, v[40:43] offset:2048
	ds_read_b64_tr_b16 v[120:121], v0 offset:20496
	ds_read_b64_tr_b16 v[122:123], v0 offset:23056
	v_exp_f32 v74, v74
	v_exp_f32 v75, v75
	v_exp_f32 v76, v76
	s_waitcnt lgkmcnt(3)
	v_mfma_f32_16x16x32_bf16 v[104:107], v[124:127], v[136:139], v[104:107]
	v_exp_f32_e64 v77, v77
	v_smfmac_f32_32x32x32_bf16 v[16:31], v[164:167], v[64:71], v87
	ds_read_b64_tr_b16 v[124:125], v0 offset:20504
	ds_read_b64_tr_b16 v[126:127], v0 offset:23064
	v_exp_f32 v78, v78
	v_exp_f32 v79, v79
	v_exp_f32 v48, v48
	s_waitcnt lgkmcnt(2)
	v_mfma_f32_16x16x32_bf16 v[108:111], v[120:123], v[136:139], v[108:111]
	v_exp_f32_e64 v49, v49
	v_smfmac_f32_32x32x32_bf16 v[16:31], v[168:171], v[72:79], v87
	s_add_u32 s66, s16, 12
	s_and_b32 s66, s66, 7
	s_mul_i32 s66, s66, 3072
	s_add_u32 s66, s66, 122880
	v_add_u32 v1, s66, v14
	s_nop 0
	ds_read_b64_tr_b16 v[120:121], v0 offset:20512
	ds_read_b64_tr_b16 v[122:123], v0 offset:23072
	v_exp_f32 v50, v50
	v_exp_f32 v51, v51
	v_exp_f32 v52, v52
	s_waitcnt lgkmcnt(2)
	v_mfma_f32_16x16x32_bf16 v[112:115], v[124:127], v[136:139], v[112:115]
	v_exp_f32_e64 v53, v53
	v_mfma_f32_32x32x16_bf16 v[64:79], v[176:179], v[88:91], 0
	ds_read_b64_tr_b16 v[124:125], v0 offset:25600
	ds_read_b64_tr_b16 v[126:127], v0 offset:28160
	s_add_u32 s66, s16, 7
	s_and_b32 s66, s66, 3
	s_lshl_b32 s66, s66, 7
	s_add_u32 s66, s66, 163328
	v_and_b32 v9, 31, v11
	v_lshlrev_b32 v9, 2, v9
	v_add_u32 v9, s66, v9
	ds_read_b32 v9, v9
	v_exp_f32 v54, v54
	v_exp_f32 v55, v55
	v_exp_f32 v56, v56
	s_waitcnt lgkmcnt(3)
	v_mfma_f32_16x16x32_bf16 v[116:119], v[120:123], v[136:139], v[116:119]
	v_exp_f32_e64 v57, v57
	v_mfma_f32_32x32x8_bf16 v[64:79], v[182:183], v[92:93], v[64:79]
	ds_read_b64_tr_b16 v[120:121], v0 offset:25608
	ds_read_b64_tr_b16 v[122:123], v0 offset:28168
	v_exp_f32 v58, v58
	v_exp_f32 v59, v59
	v_exp_f32 v60, v60
	s_setprio 1
	v_exp_f32_e64 v61, v61
	v_smfmac_f32_32x32x32_bf16 v[16:31], v[184:187], v[48:55], v87
	v_exp_f32 v62, v62
	v_exp_f32 v63, v63
	v_exp_f32 v64, v64
	s_waitcnt vmcnt(5) lgkmcnt(3)
	v_mfma_f32_16x16x32_bf16 v[100:103], v[124:127], v[80:83], v[100:103]
	v_exp_f32_e64 v65, v65
	v_smfmac_f32_32x32x32_bf16 v[16:31], v[188:191], v[56:63], v87
	s_add_u32 s66, s16, 7
	s_and_b32 s66, s66, 7
	s_mul_i32 s66, s66, 1536
	s_add_u32 s66, s66, 151040
	v_add_u32 v2, s66, v14
	v_add_u32 v3, s66, v4
	ds_read_b64_tr_b16 v[124:125], v0 offset:25616
	ds_read_b64_tr_b16 v[126:127], v0 offset:28176
	v_exp_f32 v66, v66
	v_exp_f32 v67, v67
	v_exp_f32 v68, v68
	s_waitcnt lgkmcnt(2)
	v_mfma_f32_16x16x32_bf16 v[104:107], v[120:123], v[80:83], v[104:107]
	v_exp_f32_e64 v69, v69
	v_mfma_f32_32x32x16_bf16 v[48:63], v[200:203], v[88:91], 0
	ds_read_b64_tr_b16 v[120:121], v0 offset:25624
	ds_read_b64_tr_b16 v[122:123], v0 offset:28184
	s_and_b32 s66, s62, 3
	s_lshl_b32 s66, s66, 1
	s_and_b32 s67, s19, 1
	s_add_u32 s66, s66, s67
	s_lshl_b32 s66, s66, 6
	s_add_u32 s66, s66, 163328
	v_lshrrev_b32 v10, 5, v7
	v_add_u32 v10, s66, v10
	v_xor_b32 v12, 64, v10
	ds_read_b32 v10, v10
	ds_read_b32 v12, v12
	v_exp_f32 v70, v70
	v_exp_f32 v71, v71
	v_exp_f32_e64 v72, v72
	s_setprio 0
	s_waitcnt lgkmcnt(4)
	v_mfma_f32_16x16x32_bf16 v[108:111], v[124:127], v[80:83], v[108:111]
	v_exp_f32_e64 v73, v73
	v_mfma_f32_32x32x8_bf16 v[48:63], v[208:209], v[92:93], v[48:63]
	ds_read_b64_tr_b16 v[124:125], v0 offset:25632
	ds_read_b64_tr_b16 v[126:127], v0 offset:28192
	v_exp_f32 v74, v74
	v_exp_f32 v75, v75
	v_exp_f32 v76, v76
	v_exp_f32 v77, v77
	v_smfmac_f32_32x32x32_bf16 v[16:31], v[192:195], v[64:71], v87
	v_exp_f32 v78, v78
	v_exp_f32 v79, v79
	v_exp_f32_e64 v48, v48
	s_waitcnt vmcnt(0) lgkmcnt(0)
	s_barrier
	v_mfma_f32_16x16x32_bf16 v[112:115], v[120:123], v[80:83], v[112:115]
	v_exp_f32_e64 v49, v49
	v_smfmac_f32_32x32x32_bf16 v[16:31], v[196:199], v[72:79], v87
	v_exp_f32 v50, v50
	s_setprio 3
	v_exp_f32_e64 v51, v51
	s_add_u32 m0, s59, 81920
	s_and_b32 s66, s19, 1
	s_mul_i32 s66, s66, 5120
	v_add_u32 v0, s66, v0
	v_exp_f32_e64 v52, v52
	v_mfma_f32_16x16x32_bf16 v[116:119], v[124:127], v[80:83], v[116:119]
	v_exp_f32_e64 v53, v53
	v_mfma_f32_32x32x16_bf16 v[64:79], v[204:207], v[88:91], 0
	buffer_load_dwordx4 v140, s[20:23], s58 offen lds
	v_exp_f32 v54, v54
	v_exp_f32 v55, v55
	s_add_u32 m0, s59, 82944
	v_exp_f32 v56, v56
	v_exp_f32 v57, v57
	v_mfma_f32_32x32x8_bf16 v[64:79], v[210:211], v[92:93], v[64:79]
	buffer_load_dwordx4 v141, s[20:23], s58 offen lds
	v_exp_f32 v58, v58
	v_exp_f32 v59, v59
	s_add_u32 m0, s59, 83968
	v_exp_f32 v60, v60
	v_exp_f32 v61, v61
	v_smfmac_f32_32x32x32_bf16 v[16:31], v[212:215], v[48:55], v87
	buffer_load_dwordx4 v142, s[20:23], s58 offen lds
	v_exp_f32 v62, v62
	v_exp_f32 v63, v63
	v_exp_f32 v64, v64
	v_exp_f32 v65, v65
	v_smfmac_f32_32x32x32_bf16 v[16:31], v[216:219], v[56:63], v87
	ds_read_b128 v[32:35], v1 offset:0
	v_exp_f32 v66, v66
	v_exp_f32_e64 v67, v67
	s_movk_i32 s66, 5120
	v_mul_hi_u32_u24 v82, 209716, v141
	v_mad_u32_u24 v82, v82, s66, v141
	v_mul_hi_u32_u24 v83, 209716, v142
	v_mad_u32_u24 v83, v83, s66, v142
	s_add_u32 m0, s59, 84992
	v_exp_f32 v68, v68
	v_exp_f32 v69, v69
	v_mfma_f32_32x32x16_bf16 v[48:63], v[228:231], v[88:91], 0
	ds_read_b128 v[36:39], v1 offset:1024
	buffer_load_dwordx4 v143, s[20:23], s58 offen lds
	v_exp_f32 v70, v70
	v_exp_f32 v71, v71
	v_mul_hi_u32_u24 v84, 209716, v143
	v_mad_u32_u24 v84, v84, s66, v143
	v_add_u32 v85, s66, v15
	v_exp_f32 v72, v72
	v_exp_f32_e64 v73, v73
	v_mfma_f32_32x32x8_bf16 v[48:63], v[236:237], v[92:93], v[48:63]
	ds_read_b128 v[40:43], v1 offset:2048
	v_exp_f32 v74, v74
	v_exp_f32 v75, v75
	s_add_u32 m0, s59, 86016
	v_exp_f32 v76, v76
	v_exp_f32 v77, v77
	v_smfmac_f32_32x32x32_bf16 v[16:31], v[220:223], v[64:71], v87
	buffer_load_dwordx4 v15, s[20:23], s58 offen lds
	s_mul_i32 s58, s18, 204800
	s_mul_i32 s69, s19, 51200
	s_add_u32 s58, s58, s69
	v_exp_f32 v78, v78
	v_exp_f32 v79, v79
	v_exp_f32 v48, v48
	v_exp_f32_e64 v49, v49
	v_smfmac_f32_32x32x32_bf16 v[16:31], v[224:227], v[72:79], v87
	ds_read_b128 v[94:97], v2
	v_exp_f32 v50, v50
	v_exp_f32_e64 v51, v51
	s_add_u32 m0, s59, 0
	ds_read_b64_tr_b16 v[120:121], v0 offset:40960
	v_exp_f32 v52, v52
	v_exp_f32 v53, v53
	v_mfma_f32_32x32x16_bf16 v[64:79], v[232:235], v[88:91], 0
	ds_read_b64 v[98:99], v3 offset:1024
	buffer_load_dwordx4 v140, s[28:31], s58 offen lds
	v_exp_f32 v54, v54
	v_exp_f32 v55, v55
	s_add_u32 m0, s59, 1024
	ds_read_b64_tr_b16 v[122:123], v0 offset:43520
	v_exp_f32 v56, v56
	v_exp_f32 v57, v57
	v_mfma_f32_32x32x8_bf16 v[64:79], v[238:239], v[92:93], v[64:79]
	buffer_load_dwordx4 v82, s[28:31], s58 offen lds
	v_exp_f32 v58, v58
	v_exp_f32 v59, v59
	s_add_u32 m0, s59, 2048
	ds_read_b64_tr_b16 v[124:125], v0 offset:40968
	v_exp_f32 v60, v60
	v_exp_f32 v61, v61
	v_smfmac_f32_32x32x32_bf16 v[16:31], v[240:243], v[48:55], v87
	buffer_load_dwordx4 v83, s[28:31], s58 offen lds
	v_exp_f32 v62, v62
	v_exp_f32 v63, v63
	ds_read_b64_tr_b16 v[126:127], v0 offset:43528
	v_exp_f32 v64, v64
	s_waitcnt lgkmcnt(0)
	v_exp_f32_e64 v65, v65
	v_smfmac_f32_32x32x32_bf16 v[16:31], v[244:247], v[56:63], v87
	v_exp_f32 v66, v66
	v_exp_f32 v67, v67
	s_add_u32 m0, s59, 3072
	ds_read_b64_tr_b16 v[128:129], v0 offset:40976
	v_exp_f32 v68, v68
	v_exp_f32 v69, v69
	v_mfma_f32_32x32x16_bf16 v[48:63], v[144:147], v[94:97], 0
	buffer_load_dwordx4 v84, s[28:31], s58 offen lds
	v_exp_f32 v70, v70
	v_exp_f32 v71, v71
	s_add_u32 m0, s59, 4096
	ds_read_b64_tr_b16 v[130:131], v0 offset:43536
	v_exp_f32 v72, v72
	v_exp_f32 v73, v73
	v_mfma_f32_32x32x8_bf16 v[48:63], v[152:153], v[98:99], v[48:63]
	buffer_load_dwordx4 v85, s[28:31], s58 offen lds
	s_add_u32 s58, s58, 409600
	v_exp_f32 v74, v74
	v_exp_f32 v75, v75
	ds_read_b64_tr_b16 v[132:133], v0 offset:40984
	v_exp_f32 v76, v76
	v_exp_f32 v77, v77
	v_smfmac_f32_32x32x32_bf16 v[16:31], v[248:251], v[64:71], v87
	v_exp_f32 v78, v78
	v_exp_f32 v79, v79
	ds_read_b64_tr_b16 v[134:135], v0 offset:43544
	v_exp_f32 v48, v48
	v_exp_f32 v49, v49
	v_smfmac_f32_32x32x32_bf16 v[16:31], v[252:255], v[72:79], v87
	v_exp_f32 v50, v50
	v_exp_f32_e64 v51, v51
	s_cmp_eq_u32 s18, 0
	s_cselect_b64 vcc, -1, 0
	s_movk_i32 s71, 20480
	ds_read_b64_tr_b16 v[136:137], v0 offset:40992
	v_exp_f32 v52, v52
	v_exp_f32 v53, v53
	v_mfma_f32_32x32x16_bf16 v[64:79], v[148:151], v[94:97], 0
	v_exp_f32 v54, v54
	v_exp_f32_e64 v55, v55
	v_cndmask_b32 v91, v140, v143, vcc
	v_mul_hi_u32_u24 v88, 838861, v91
	v_mad_u32_u24 v88, v88, s71, v91
	ds_read_b64_tr_b16 v[138:139], v0 offset:43552
	v_exp_f32 v56, v56
	v_exp_f32 v57, v57
	v_mfma_f32_32x32x8_bf16 v[64:79], v[154:155], v[98:99], v[64:79]
	v_exp_f32 v58, v58
	v_exp_f32_e64 v59, v59
	v_cndmask_b32 v91, v141, v15, vcc
	v_mul_hi_u32_u24 v89, 838861, v91
	v_mad_u32_u24 v89, v89, s71, v91
	v_exp_f32 v60, v60
	v_exp_f32 v61, v61
	v_smfmac_f32_32x32x32_bf16 v[32:47], v[156:159], v[48:55], v87
	v_exp_f32 v62, v62
	v_exp_f32 v63, v63
	v_mul_hi_u32_u24 v90, 838861, v142
	v_mad_u32_u24 v90, v90, s71, v142
	v_exp_f32 v64, v64
	s_setprio 2
	v_exp_f32_e64 v65, v65
	v_smfmac_f32_32x32x32_bf16 v[32:47], v[160:163], v[56:63], v87
	ds_write_b128 v1, v[16:19] offset:0
	v_exp_f32 v66, v66
	v_exp_f32 v67, v67
	ds_read_b64_tr_b16 v[144:145], v0 offset:61440
	v_exp_f32 v68, v68
	v_exp_f32 v69, v69
	v_mfma_f32_32x32x16_bf16 v[48:63], v[172:175], v[94:97], 0
	ds_write_b128 v1, v[20:23] offset:1024
	v_exp_f32 v70, v70
	v_exp_f32 v71, v71
	ds_read_b64_tr_b16 v[146:147], v0 offset:64000
	v_exp_f32 v72, v72
	v_exp_f32 v73, v73
	v_mfma_f32_32x32x8_bf16 v[48:63], v[180:181], v[98:99], v[48:63]
	ds_write_b128 v1, v[24:27] offset:2048
	v_exp_f32 v74, v74
	v_exp_f32 v75, v75
	ds_read_b64_tr_b16 v[148:149], v0 offset:61448
	v_exp_f32 v76, v76
	v_exp_f32 v77, v77
	v_smfmac_f32_32x32x32_bf16 v[32:47], v[164:167], v[64:71], v87
	buffer_load_dwordx4 v[164:167], v5, s[24:27], s60 offen sc1
	v_exp_f32 v78, v78
	v_exp_f32 v79, v79
	ds_read_b64_tr_b16 v[150:151], v0 offset:64008
	v_exp_f32 v48, v48
	v_exp_f32 v49, v49
	v_smfmac_f32_32x32x32_bf16 v[32:47], v[168:171], v[72:79], v87
	s_add_u32 s66, s16, 13
	s_and_b32 s66, s66, 7
	s_mul_i32 s66, s66, 3072
	s_add_u32 s66, s66, 122880
	v_add_u32 v1, s66, v14
	s_nop 0
	buffer_load_dwordx4 v[168:171], v6, s[24:27], s60 offen sc1
	s_add_u32 s60, s60, 4096
	v_exp_f32 v50, v50
	v_exp_f32 v51, v51
	ds_read_b64_tr_b16 v[152:153], v0 offset:61456
	v_exp_f32 v52, v52
	v_exp_f32 v53, v53
	v_mfma_f32_32x32x16_bf16 v[64:79], v[176:179], v[94:97], 0
	v_exp_f32 v54, v54
	v_exp_f32 v55, v55
	ds_read_b64_tr_b16 v[154:155], v0 offset:64016
	v_exp_f32 v56, v56
	v_exp_f32 v57, v57
	v_mfma_f32_32x32x8_bf16 v[64:79], v[182:183], v[98:99], v[64:79]
	buffer_load_dwordx4 v[172:175], v5, s[24:27], s60 offen sc1
	v_exp_f32 v58, v58
	v_exp_f32 v59, v59
	ds_read_b64_tr_b16 v[156:157], v0 offset:61464
	v_exp_f32 v60, v60
	s_setprio 1
	v_exp_f32_e64 v61, v61
	v_smfmac_f32_32x32x32_bf16 v[32:47], v[184:187], v[48:55], v87
	buffer_load_dwordx4 v[176:179], v6, s[24:27], s60 offen sc1
	s_add_u32 s60, s60, 4096
	v_exp_f32 v62, v62
	v_exp_f32 v63, v63
	ds_read_b64_tr_b16 v[158:159], v0 offset:64024
	v_exp_f32 v64, v64
	v_exp_f32 v65, v65
	v_smfmac_f32_32x32x32_bf16 v[32:47], v[188:191], v[56:63], v87
	buffer_load_dwordx4 v[180:183], v5, s[24:27], s60 offen sc1
	v_exp_f32 v66, v66
	v_exp_f32 v67, v67
	ds_read_b64_tr_b16 v[160:161], v0 offset:61472
	v_exp_f32 v68, v68
	v_exp_f32 v69, v69
	v_mfma_f32_32x32x16_bf16 v[48:63], v[200:203], v[94:97], 0
	buffer_load_dwordx4 v[184:187], v6, s[24:27], s60 offen sc1
	s_add_u32 s60, s60, 4096
	v_exp_f32 v70, v70
	v_exp_f32 v71, v71
	ds_read_b64_tr_b16 v[162:163], v0 offset:64032
	v_exp_f32 v72, v72
	s_setprio 0
	v_exp_f32_e64 v73, v73
	v_mfma_f32_32x32x8_bf16 v[48:63], v[208:209], v[98:99], v[48:63]
	buffer_load_dwordx4 v[188:191], v5, s[24:27], s60 offen sc1
	v_exp_f32 v74, v74
	v_exp_f32 v75, v75
	v_exp_f32 v76, v76
	v_exp_f32 v77, v77
	v_smfmac_f32_32x32x32_bf16 v[32:47], v[192:195], v[64:71], v87
	buffer_load_dwordx4 v[192:195], v6, s[24:27], s60 offen sc1
	s_add_u32 s60, s60, 4096
	v_exp_f32 v78, v78
	v_exp_f32 v79, v79
	v_exp_f32 v48, v48
	s_waitcnt vmcnt(8) lgkmcnt(0)
	s_barrier
	v_exp_f32 v49, v49
	v_smfmac_f32_32x32x32_bf16 v[32:47], v[196:199], v[72:79], v87
	v_exp_f32 v50, v50
	s_setprio 3
	v_exp_f32_e64 v51, v51
	s_add_u32 m0, s59, 40960
	v_exp_f32 v52, v52
	v_exp_f32 v53, v53
	v_mfma_f32_32x32x16_bf16 v[64:79], v[204:207], v[94:97], 0
	buffer_load_dwordx4 v140, s[28:31], s58 offen lds
	v_exp_f32 v54, v54
	v_exp_f32 v55, v55
	s_add_u32 m0, s59, 41984
	v_exp_f32 v56, v56
	v_exp_f32 v57, v57
	v_mfma_f32_32x32x8_bf16 v[64:79], v[210:211], v[98:99], v[64:79]
	buffer_load_dwordx4 v82, s[28:31], s58 offen lds
	v_exp_f32 v58, v58
	v_exp_f32 v59, v59
	s_add_u32 m0, s59, 43008
	v_exp_f32 v60, v60
	v_exp_f32 v61, v61
	v_smfmac_f32_32x32x32_bf16 v[32:47], v[212:215], v[48:55], v87
	buffer_load_dwordx4 v83, s[28:31], s58 offen lds
	v_exp_f32 v62, v62
	v_exp_f32 v63, v63
	v_exp_f32 v64, v64
	v_exp_f32 v65, v65
	v_smfmac_f32_32x32x32_bf16 v[32:47], v[216:219], v[56:63], v87
	ds_read_b128 v[16:19], v1 offset:0
	v_exp_f32 v66, v66
	v_exp_f32 v67, v67
	s_add_u32 m0, s59, 44032
	v_exp_f32 v68, v68
	v_exp_f32 v69, v69
	v_mfma_f32_32x32x16_bf16 v[48:63], v[228:231], v[94:97], 0
	ds_read_b128 v[20:23], v1 offset:1024
	buffer_load_dwordx4 v84, s[28:31], s58 offen lds
	v_exp_f32 v70, v70
	v_exp_f32 v71, v71
	v_exp_f32 v72, v72
	v_exp_f32 v73, v73
	v_mfma_f32_32x32x8_bf16 v[48:63], v[236:237], v[98:99], v[48:63]
	ds_read_b128 v[24:27], v1 offset:2048
	v_exp_f32 v74, v74
	v_exp_f32 v75, v75
	s_add_u32 m0, s59, 45056
	v_exp_f32 v76, v76
	v_exp_f32 v77, v77
	v_smfmac_f32_32x32x32_bf16 v[32:47], v[220:223], v[64:71], v87
	buffer_load_dwordx4 v85, s[28:31], s58 offen lds
	s_add_u32 s69, s16, 13
	s_and_b32 s69, s69, 7
	s_mul_i32 s59, s69, 3072
	s_lshr_b32 s69, s69, 1
	s_mul_i32 s58, s69, 204800
	s_add_u32 s58, s58, 20480
	v_exp_f32 v78, v78
	v_exp_f32 v79, v79
	v_exp_f32 v48, v48
	v_exp_f32_e64 v49, v49
	v_smfmac_f32_32x32x32_bf16 v[32:47], v[224:227], v[72:79], v87
	v_exp_f32 v50, v50
	v_exp_f32_e64 v51, v51
	s_waitcnt lgkmcnt(0)
	s_add_u32 m0, s59, 124928
	v_exp_f32 v52, v52
	v_exp_f32 v53, v53
	v_mfma_f32_32x32x16_bf16 v[64:79], v[232:235], v[94:97], 0
	s_cbranch_vccnz L_w16
	s_nop 0
	buffer_load_dwordx4 v90, s[28:31], s58 offen lds
L_w16:
	v_exp_f32 v54, v54
	v_exp_f32 v55, v55
	s_add_u32 m0, s59, 122880
	v_exp_f32 v56, v56
	s_setprio 2
	v_exp_f32_e64 v57, v57
	v_mfma_f32_32x32x8_bf16 v[64:79], v[238:239], v[98:99], v[64:79]
	buffer_load_dwordx4 v88, s[28:31], s58 offen lds
	v_exp_f32 v58, v58
	v_exp_f32 v59, v59
	s_add_u32 m0, s59, 123904
	v_exp_f32 v60, v60
	v_exp_f32 v61, v61
	v_smfmac_f32_32x32x32_bf16 v[32:47], v[240:243], v[48:55], v87
	buffer_load_dwordx4 v89, s[28:31], s58 offen lds
	v_exp_f32 v62, v62
	v_exp_f32 v63, v63
	v_exp_f32 v64, v64
	s_waitcnt lgkmcnt(0)
	v_exp_f32_e64 v65, v65
	v_smfmac_f32_32x32x32_bf16 v[32:47], v[244:247], v[56:63], v87
	v_exp_f32 v66, v66
	v_exp_f32 v67, v67
	v_exp_f32 v68, v68
	v_exp_f32 v69, v69
	v_exp_f32 v70, v70
	s_setprio 1
	v_exp_f32 v71, v71
	v_exp_f32 v72, v72
	v_exp_f32 v73, v73
	v_exp_f32 v74, v74
	v_exp_f32 v75, v75
	v_exp_f32 v76, v76
	s_setprio 0
	v_exp_f32 v77, v77
	v_smfmac_f32_32x32x32_bf16 v[32:47], v[248:251], v[64:71], v87
	v_exp_f32 v78, v78
	v_exp_f32 v79, v79
L_attn_end:
	s_setprio 0
	s_nop 0
	v_smfmac_f32_32x32x32_bf16 v[32:47], v[252:255], v[72:79], v87
	s_add_u32 s66, s16, 7
	s_bfe_u32 s67, s66, 0x10002
	s_and_b32 s66, s66, 3
	s_lshl_b32 s68, s3, 2
	s_add_u32 s66, s66, s68
	s_mul_i32 s66, s66, 40960
	s_add_u32 s64, s66, 7340032
	s_lshl1_add_u32 s67, s17, s67
	s_lshl_b32 s68, s67, 7
	s_add_u32 s65, s64, s68
	s_add_u32 s65, s65, 16384
	s_lshl_b32 s68, s67, 9
	s_add_u32 s64, s64, s68
	v_bfe_u32 v49, v11, 4, 1
	v_mul_u32_u24 v49, 20480, v49
	v_lshrrev_b32 v50, 4, v7
	v_add_u32 v4, v49, v50
	v_and_b32 v49, 32, v11
	v_lshl_add_u32 v49, v49, 3, v50
	v_add_u32 v1, v49, v4
	v_pk_add_f32 v[32:33], v[32:33], v[16:17]
	v_pk_add_f32 v[34:35], v[34:35], v[18:19]
	v_pk_add_f32 v[36:37], v[36:37], v[20:21]
	v_pk_add_f32 v[38:39], v[38:39], v[22:23]
	v_pk_add_f32 v[40:41], v[40:41], v[24:25]
	v_pk_add_f32 v[42:43], v[42:43], v[26:27]
L_fin:
	v_mov_b32 v48, v40
	v_mov_b32 v49, v40
	s_nop 1
	v_permlane32_swap_b32 v48, v49
	v_rcp_f32 v50, v49
	s_nop 0
	v_mul_f32 v50, v50, v9
	v_pk_mul_f32 v[16:17], v[32:33], v[50:51] op_sel_hi:[1,0]
	v_pk_mul_f32 v[18:19], v[34:35], v[50:51] op_sel_hi:[1,0]
	v_pk_mul_f32 v[20:21], v[36:37], v[50:51] op_sel_hi:[1,0]
	v_pk_mul_f32 v[22:23], v[38:39], v[50:51] op_sel_hi:[1,0]
	v_pk_mul_f32 v[24:25], v[40:41], v[50:51] op_sel_hi:[1,0]
	v_pk_mul_f32 v[26:27], v[42:43], v[50:51] op_sel_hi:[1,0]
	v_mov_b32 v52, 0
	v_mov_b32 v53, 0
	v_pk_mul_f32 v[54:55], v[16:17], v[52:53]
	v_pk_fma_f32 v[54:55], v[18:19], v[52:53], v[54:55]
	v_pk_fma_f32 v[54:55], v[20:21], v[52:53], v[54:55]
	v_pk_fma_f32 v[54:55], v[22:23], v[52:53], v[54:55]
	v_pk_fma_f32 v[54:55], v[24:25], v[52:53], v[54:55]
	v_pk_fma_f32 v[54:55], v[26:27], v[52:53], v[54:55]
	v_cvt_pk_bf16_f32 v56, v16, v17
	v_cvt_pk_bf16_f32 v57, v18, v19
	v_cvt_pk_bf16_f32 v58, v20, v21
	v_cvt_pk_bf16_f32 v59, v22, v23
	v_cvt_pk_bf16_f32 v60, v24, v25
	v_cvt_pk_bf16_f32 v61, v26, v27
	v_add_f32 v54, v54, v55
	v_add_f32 v54, v54, v49
	v_mov_b32 v52, 0x2b800000
	v_mov_b32 v53, 0x53800000
	v_med3_f32 v52, v54, v52, v53
	v_cmp_neq_f32 vcc, v52, v54
	s_nop 1
	s_and_b64 vcc, vcc, s[74:75]
	s_cbranch_scc1 L_fallback
	buffer_store_dwordx4 v[56:59], v1, s[24:27], s64 offen sc1
	s_mov_b64 exec, 0xffffffff
	buffer_store_dwordx2 v[60:61], v4, s[24:27], s65 offen sc1
	s_mov_b64 exec, -1
	s_and_b32 s76, s19, 1
	s_mul_i32 s76, s76, 20480
	v_add_u32 v5, s76, v14
	s_sub_u32 s76, 20480, s76
	v_add_u32 v6, s76, v14
	s_mul_i32 s64, s62, 40960
	s_lshl_b32 s76, s19, 10
	s_add_u32 s64, s64, s76
	s_add_u32 s64, s64, 7340032
	v_lshrrev_b32 v99, 4, v7
	v_sub_u32 v8, v5, v99
	v_sub_u32 v9, v6, v99
	s_add_u32 s65, s64, 4096
	s_add_u32 s66, s64, 8192
	s_add_u32 s67, s64, 12288
	s_add_u32 s68, s64, 16384
	v_sub_f32 v10, 1.0, v10
	v_sub_f32 v12, 1.0, v12
	v_add_u32 v2, 81920, v0
	s_waitcnt vmcnt(4)
	s_barrier
	v_mfma_f32_16x16x32_bf16 v[100:103], v[120:123], v[164:167], v[100:103]
	s_mov_b32 s70, 32768
	s_lshl_b32 s76, s19, 10
	s_add_u32 s76, s76, 122880
	v_add_u32 v3, s76, v0
	v_mfma_f32_16x16x32_bf16 v[36:39], v[120:123], v[168:171], 0
	s_mov_b32 s78, 0x5004b47
	s_cmp_eq_u32 s18, 1
	s_cselect_b32 s78, 0x37322d28, s78
	v_mfma_f32_16x16x32_bf16 v[104:107], v[124:127], v[164:167], v[104:107]
	s_xor_b32 s76, s19, 0
	s_lshl_b32 s76, s76, 3
	s_lshr_b32 s76, s78, s76
	s_and_b32 s76, s76, 255
	s_lshl_b32 s76, s76, 11
	v_add_u32 v88, s76, v14
	v_mfma_f32_16x16x32_bf16 v[40:43], v[124:127], v[168:171], 0
	s_xor_b32 s76, s19, 1
	s_lshl_b32 s76, s76, 3
	s_lshr_b32 s76, s78, s76
	s_and_b32 s76, s76, 255
	s_lshl_b32 s76, s76, 11
	s_add_u32 s76, s76, 5120
	v_add_u32 v89, s76, v14
	v_mfma_f32_16x16x32_bf16 v[108:111], v[128:131], v[164:167], v[108:111]
	s_xor_b32 s76, s19, 2
	s_lshl_b32 s76, s76, 3
	s_lshr_b32 s76, s78, s76
	s_and_b32 s76, s76, 255
	s_lshl_b32 s76, s76, 11
	v_add_u32 v90, s76, v14
	v_mfma_f32_16x16x32_bf16 v[44:47], v[128:131], v[168:171], 0
	s_xor_b32 s76, s19, 3
	s_lshl_b32 s76, s76, 3
	s_lshr_b32 s76, s78, s76
	s_and_b32 s76, s76, 255
	s_lshl_b32 s76, s76, 11
	s_add_u32 s76, s76, 5120
	v_add_u32 v91, s76, v14
	v_mfma_f32_16x16x32_bf16 v[112:115], v[132:135], v[164:167], v[112:115]
	s_and_b32 s76, s19, 1
	s_lshl1_add_u32 s76, s62, s76
	s_mul_i32 s76, s76, 20480
	s_add_u32 s63, s76, s43
	s_add_u32 s4, s52, 0
	s_addc_u32 s5, s53, 0
	s_mov_b32 s6, 2621440
	s_mov_b32 s7, 0x00020000
	v_mfma_f32_16x16x32_bf16 v[48:51], v[132:135], v[168:171], 0
	v_mul_u32_u24 v92, 10, v7
	v_lshrrev_b32 v93, 4, v11
	v_mad_u32_u24 v92, v93, 40, v92
	v_mfma_f32_16x16x32_bf16 v[116:119], v[136:139], v[164:167], v[116:119]
	v_mfma_f32_16x16x32_bf16 v[52:55], v[136:139], v[168:171], 0
	v_mfma_f32_16x16x32_bf16 v[100:103], v[144:147], v[172:175], v[100:103]
	ds_read_b64_tr_b16 v[120:121], v2 offset:0
	v_mfma_f32_16x16x32_bf16 v[36:39], v[144:147], v[176:179], v[36:39]
	ds_read_b64_tr_b16 v[122:123], v2 offset:2560
	v_mfma_f32_16x16x32_bf16 v[104:107], v[148:151], v[172:175], v[104:107]
	ds_read_b64_tr_b16 v[124:125], v2 offset:8
	v_mfma_f32_16x16x32_bf16 v[40:43], v[148:151], v[176:179], v[40:43]
	ds_read_b64_tr_b16 v[126:127], v2 offset:2568
	v_mfma_f32_16x16x32_bf16 v[108:111], v[152:155], v[172:175], v[108:111]
	ds_read_b64_tr_b16 v[128:129], v2 offset:16
	buffer_load_dwordx4 v[200:203], v5, s[24:27], s64 offen sc1
	v_mfma_f32_16x16x32_bf16 v[44:47], v[152:155], v[176:179], v[44:47]
	ds_read_b64_tr_b16 v[130:131], v2 offset:2576
	v_mfma_f32_16x16x32_bf16 v[112:115], v[156:159], v[172:175], v[112:115]
	ds_read_b64_tr_b16 v[132:133], v2 offset:24
	v_mfma_f32_16x16x32_bf16 v[48:51], v[156:159], v[176:179], v[48:51]
	ds_read_b64_tr_b16 v[134:135], v2 offset:2584
	v_mfma_f32_16x16x32_bf16 v[116:119], v[160:163], v[172:175], v[116:119]
	ds_read_b64_tr_b16 v[136:137], v2 offset:32
	v_mfma_f32_16x16x32_bf16 v[52:55], v[160:163], v[176:179], v[52:55]
	ds_read_b64_tr_b16 v[138:139], v2 offset:2592
	buffer_load_dwordx4 v[204:207], v6, s[24:27], s64 offen sc1
	s_waitcnt lgkmcnt(8)
	v_mfma_f32_16x16x32_bf16 v[100:103], v[120:123], v[180:183], v[100:103]
	ds_read_b64_tr_b16 v[144:145], v2 offset:20480
	v_mfma_f32_16x16x32_bf16 v[36:39], v[120:123], v[184:187], v[36:39]
	ds_read_b64_tr_b16 v[146:147], v2 offset:23040
	s_waitcnt lgkmcnt(8)
	v_mfma_f32_16x16x32_bf16 v[104:107], v[124:127], v[180:183], v[104:107]
	ds_read_b64_tr_b16 v[148:149], v2 offset:20488
	v_mfma_f32_16x16x32_bf16 v[40:43], v[124:127], v[184:187], v[40:43]
	ds_read_b64_tr_b16 v[150:151], v2 offset:23048
	s_waitcnt lgkmcnt(8)
	v_mfma_f32_16x16x32_bf16 v[108:111], v[128:131], v[180:183], v[108:111]
	ds_read_b64_tr_b16 v[152:153], v2 offset:20496
	buffer_load_dwordx4 v[208:211], v5, s[24:27], s65 offen sc1
	v_mfma_f32_16x16x32_bf16 v[44:47], v[128:131], v[184:187], v[44:47]
	ds_read_b64_tr_b16 v[154:155], v2 offset:23056
	s_waitcnt lgkmcnt(8)
	v_mfma_f32_16x16x32_bf16 v[112:115], v[132:135], v[180:183], v[112:115]
	ds_read_b64_tr_b16 v[156:157], v2 offset:20504
	v_mfma_f32_16x16x32_bf16 v[48:51], v[132:135], v[184:187], v[48:51]
	ds_read_b64_tr_b16 v[158:159], v2 offset:23064
	s_waitcnt lgkmcnt(8)
	v_mfma_f32_16x16x32_bf16 v[116:119], v[136:139], v[180:183], v[116:119]
	ds_read_b64_tr_b16 v[160:161], v2 offset:20512
	v_mfma_f32_16x16x32_bf16 v[52:55], v[136:139], v[184:187], v[52:55]
	ds_read_b64_tr_b16 v[162:163], v2 offset:23072
	buffer_load_dwordx4 v[212:215], v6, s[24:27], s65 offen sc1
	s_waitcnt lgkmcnt(8)
	v_mfma_f32_16x16x32_bf16 v[100:103], v[144:147], v[188:191], v[100:103]
	ds_read_b64_tr_b16 v[120:121], v0 offset:0
	v_mfma_f32_16x16x32_bf16 v[36:39], v[144:147], v[192:195], v[36:39]
	ds_read_b64_tr_b16 v[122:123], v0 offset:2560
	s_waitcnt lgkmcnt(8)
	v_mfma_f32_16x16x32_bf16 v[104:107], v[148:151], v[188:191], v[104:107]
	ds_read_b64_tr_b16 v[124:125], v0 offset:8
	v_mfma_f32_16x16x32_bf16 v[40:43], v[148:151], v[192:195], v[40:43]
	ds_read_b64_tr_b16 v[126:127], v0 offset:2568
	s_waitcnt lgkmcnt(8)
	v_mfma_f32_16x16x32_bf16 v[108:111], v[152:155], v[188:191], v[108:111]
	ds_read_b64_tr_b16 v[128:129], v0 offset:16
	buffer_load_dwordx4 v[216:219], v5, s[24:27], s66 offen sc1
	v_mul_f32 v100, v10, v100
	v_mul_f32 v101, v10, v101
	v_mul_f32 v102, v10, v102
	v_mul_f32 v103, v10, v103
	v_mfma_f32_16x16x32_bf16 v[44:47], v[152:155], v[192:195], v[44:47]
	ds_read_b64_tr_b16 v[130:131], v0 offset:2576
	v_mul_f32 v36, v12, v36
	v_mul_f32 v37, v12, v37
	v_mul_f32 v38, v12, v38
	v_mul_f32 v39, v12, v39
	s_waitcnt lgkmcnt(8)
	v_mfma_f32_16x16x32_bf16 v[112:115], v[156:159], v[188:191], v[112:115]
	ds_read_b64_tr_b16 v[132:133], v0 offset:24
	v_mul_f32 v104, v10, v104
	v_mul_f32 v105, v10, v105
	v_mul_f32 v106, v10, v106
	v_mul_f32 v107, v10, v107
	v_mfma_f32_16x16x32_bf16 v[48:51], v[156:159], v[192:195], v[48:51]
	ds_read_b64_tr_b16 v[134:135], v0 offset:2584
	v_mul_f32 v40, v12, v40
	v_mul_f32 v41, v12, v41
	v_mul_f32 v42, v12, v42
	v_mul_f32 v43, v12, v43
	s_waitcnt lgkmcnt(8)
	v_mfma_f32_16x16x32_bf16 v[116:119], v[160:163], v[188:191], v[116:119]
	ds_read_b64_tr_b16 v[136:137], v0 offset:32
	v_mul_f32 v108, v10, v108
	v_mul_f32 v109, v10, v109
	v_mul_f32 v110, v10, v110
	v_mul_f32 v111, v10, v111
	v_mfma_f32_16x16x32_bf16 v[52:55], v[160:163], v[192:195], v[52:55]
	ds_read_b64_tr_b16 v[138:139], v0 offset:2592
	buffer_load_dwordx4 v[220:223], v6, s[24:27], s66 offen sc1
	v_mul_f32 v44, v12, v44
	v_mul_f32 v45, v12, v45
	v_mul_f32 v46, v12, v46
	v_mul_f32 v47, v12, v47
	s_waitcnt vmcnt(4) lgkmcnt(8)
	s_movk_i32 s71, 12
L_oc12:
	v_max3_u32 v96, v200, v202, v204
	v_max_u32 v96, v96, v206
	v_cmp_eq_u32 vcc, -1, v96
	s_cbranch_vccnz L_retry
L_od12:
	v_mfma_f32_16x16x32_bf16 v[100:103], v[120:123], v[200:203], v[100:103]
	ds_read_b64_tr_b16 v[144:145], v0 offset:20480
	v_mul_f32 v112, v10, v112
	v_mul_f32 v113, v10, v113
	v_mul_f32 v114, v10, v114
	v_mul_f32 v115, v10, v115
	v_mfma_f32_16x16x32_bf16 v[36:39], v[120:123], v[204:207], v[36:39]
	ds_read_b64_tr_b16 v[146:147], v0 offset:23040
	v_mul_f32 v48, v12, v48
	v_mul_f32 v49, v12, v49
	v_mul_f32 v50, v12, v50
	v_mul_f32 v51, v12, v51
	s_waitcnt lgkmcnt(8)
	v_mfma_f32_16x16x32_bf16 v[104:107], v[124:127], v[200:203], v[104:107]
	ds_read_b64_tr_b16 v[148:149], v0 offset:20488
	v_mul_f32 v116, v10, v116
	v_mul_f32 v117, v10, v117
	v_mul_f32 v118, v10, v118
	v_mul_f32 v119, v10, v119
	v_mfma_f32_16x16x32_bf16 v[40:43], v[124:127], v[204:207], v[40:43]
	ds_read_b64_tr_b16 v[150:151], v0 offset:23048
	v_mul_f32 v52, v12, v52
	v_mul_f32 v53, v12, v53
	v_mul_f32 v54, v12, v54
	v_mul_f32 v55, v12, v55
	s_waitcnt lgkmcnt(8)
	v_mfma_f32_16x16x32_bf16 v[108:111], v[128:131], v[200:203], v[108:111]
	ds_read_b64_tr_b16 v[152:153], v0 offset:20496
	buffer_load_dwordx4 v[224:227], v5, s[24:27], s67 offen sc1
	v_mfma_f32_16x16x32_bf16 v[44:47], v[128:131], v[204:207], v[44:47]
	ds_read_b64_tr_b16 v[154:155], v0 offset:23056
	s_waitcnt lgkmcnt(8)
	v_mfma_f32_16x16x32_bf16 v[112:115], v[132:135], v[200:203], v[112:115]
	ds_read_b64_tr_b16 v[156:157], v0 offset:20504
	v_mfma_f32_16x16x32_bf16 v[48:51], v[132:135], v[204:207], v[48:51]
	ds_read_b64_tr_b16 v[158:159], v0 offset:23064
	s_waitcnt lgkmcnt(8)
	v_mfma_f32_16x16x32_bf16 v[116:119], v[136:139], v[200:203], v[116:119]
	ds_read_b64_tr_b16 v[160:161], v0 offset:20512
	v_mfma_f32_16x16x32_bf16 v[52:55], v[136:139], v[204:207], v[52:55]
	ds_read_b64_tr_b16 v[162:163], v0 offset:23072
	buffer_load_dwordx4 v[228:231], v6, s[24:27], s67 offen sc1
	s_waitcnt vmcnt(4) lgkmcnt(8)
	s_movk_i32 s71, 13
L_oc13:
	v_max3_u32 v96, v208, v210, v212
	v_max_u32 v96, v96, v214
	v_cmp_eq_u32 vcc, -1, v96
	s_cbranch_vccnz L_retry
L_od13:
	v_mfma_f32_16x16x32_bf16 v[100:103], v[144:147], v[208:211], v[100:103]
	ds_read_b64_tr_b16 v[120:121], v0 offset:40960
	v_mfma_f32_16x16x32_bf16 v[36:39], v[144:147], v[212:215], v[36:39]
	ds_read_b64_tr_b16 v[122:123], v0 offset:43520
	s_waitcnt lgkmcnt(8)
	v_mfma_f32_16x16x32_bf16 v[104:107], v[148:151], v[208:211], v[104:107]
	ds_read_b64_tr_b16 v[124:125], v0 offset:40968
	v_mfma_f32_16x16x32_bf16 v[40:43], v[148:151], v[212:215], v[40:43]
	ds_read_b64_tr_b16 v[126:127], v0 offset:43528
	s_waitcnt lgkmcnt(8)
	v_mfma_f32_16x16x32_bf16 v[108:111], v[152:155], v[208:211], v[108:111]
	ds_read_b64_tr_b16 v[128:129], v0 offset:40976
	buffer_load_dwordx2 v[232:233], v8, s[24:27], s68 offen offset:0 sc1
	buffer_load_dwordx2 v[234:235], v8, s[24:27], s68 offen offset:128 sc1
	v_mfma_f32_16x16x32_bf16 v[44:47], v[152:155], v[212:215], v[44:47]
	ds_read_b64_tr_b16 v[130:131], v0 offset:43536
	s_waitcnt lgkmcnt(8)
	v_mfma_f32_16x16x32_bf16 v[112:115], v[156:159], v[208:211], v[112:115]
	ds_read_b64_tr_b16 v[132:133], v0 offset:40984
	v_mfma_f32_16x16x32_bf16 v[48:51], v[156:159], v[212:215], v[48:51]
	ds_read_b64_tr_b16 v[134:135], v0 offset:43544
	s_waitcnt lgkmcnt(8)
	v_mfma_f32_16x16x32_bf16 v[116:119], v[160:163], v[208:211], v[116:119]
	ds_read_b64_tr_b16 v[136:137], v0 offset:40992
	v_mfma_f32_16x16x32_bf16 v[52:55], v[160:163], v[212:215], v[52:55]
	ds_read_b64_tr_b16 v[138:139], v0 offset:43552
	buffer_load_dwordx2 v[236:237], v9, s[24:27], s68 offen offset:0 sc1
	buffer_load_dwordx2 v[238:239], v9, s[24:27], s68 offen offset:128 sc1
	s_waitcnt vmcnt(6) lgkmcnt(8)
	s_movk_i32 s71, 14
L_oc14:
	v_max3_u32 v96, v216, v218, v220
	v_max_u32 v96, v96, v222
	v_cmp_eq_u32 vcc, -1, v96
	s_cbranch_vccnz L_retry
L_od14:
	v_mfma_f32_16x16x32_bf16 v[100:103], v[120:123], v[216:219], v[100:103]
	ds_read_b64_tr_b16 v[144:145], v0 offset:61440
	v_mfma_f32_16x16x32_bf16 v[36:39], v[120:123], v[220:223], v[36:39]
	ds_read_b64_tr_b16 v[146:147], v0 offset:64000
	s_waitcnt lgkmcnt(8)
	v_mfma_f32_16x16x32_bf16 v[104:107], v[124:127], v[216:219], v[104:107]
	ds_read_b64_tr_b16 v[148:149], v0 offset:61448
	v_mfma_f32_16x16x32_bf16 v[40:43], v[124:127], v[220:223], v[40:43]
	ds_read_b64_tr_b16 v[150:151], v0 offset:64008
	s_waitcnt lgkmcnt(8)
	v_mfma_f32_16x16x32_bf16 v[108:111], v[128:131], v[216:219], v[108:111]
	ds_read_b64_tr_b16 v[152:153], v0 offset:61456
	v_mfma_f32_16x16x32_bf16 v[44:47], v[128:131], v[220:223], v[44:47]
	ds_read_b64_tr_b16 v[154:155], v0 offset:64016
	s_waitcnt lgkmcnt(8)
	v_mfma_f32_16x16x32_bf16 v[112:115], v[132:135], v[216:219], v[112:115]
	ds_read_b64_tr_b16 v[156:157], v0 offset:61464
	v_mfma_f32_16x16x32_bf16 v[48:51], v[132:135], v[220:223], v[48:51]
	ds_read_b64_tr_b16 v[158:159], v0 offset:64024
	s_waitcnt lgkmcnt(8)
	v_mfma_f32_16x16x32_bf16 v[116:119], v[136:139], v[216:219], v[116:119]
	ds_read_b64_tr_b16 v[160:161], v0 offset:61472
	v_mfma_f32_16x16x32_bf16 v[52:55], v[136:139], v[220:223], v[52:55]
	ds_read_b64_tr_b16 v[162:163], v0 offset:64032
	s_waitcnt lgkmcnt(0)
	s_barrier
	s_waitcnt vmcnt(4)
	s_movk_i32 s71, 15
L_oc15:
	v_max3_u32 v96, v224, v226, v228
	v_max_u32 v96, v96, v230
	v_cmp_eq_u32 vcc, -1, v96
	s_cbranch_vccnz L_retry
L_od15:
	v_mfma_f32_16x16x32_bf16 v[100:103], v[144:147], v[224:227], v[100:103]
	ds_read_b64_tr_b16 v[120:121], v3 offset:0
	v_mfma_f32_16x16x32_bf16 v[36:39], v[144:147], v[228:231], v[36:39]
	ds_read_b64_tr_b16 v[122:123], v3 offset:2560
	v_mfma_f32_16x16x32_bf16 v[104:107], v[148:151], v[224:227], v[104:107]
	ds_read_b64_tr_b16 v[124:125], v3 offset:8
	v_mfma_f32_16x16x32_bf16 v[40:43], v[148:151], v[228:231], v[40:43]
	ds_read_b64_tr_b16 v[126:127], v3 offset:2568
	v_mfma_f32_16x16x32_bf16 v[108:111], v[152:155], v[224:227], v[108:111]
	ds_read_b64_tr_b16 v[128:129], v3 offset:16
	v_mfma_f32_16x16x32_bf16 v[44:47], v[152:155], v[228:231], v[44:47]
	ds_read_b64_tr_b16 v[130:131], v3 offset:2576
	v_mfma_f32_16x16x32_bf16 v[112:115], v[156:159], v[224:227], v[112:115]
	ds_read_b64_tr_b16 v[132:133], v3 offset:24
	v_mfma_f32_16x16x32_bf16 v[48:51], v[156:159], v[228:231], v[48:51]
	ds_read_b64_tr_b16 v[134:135], v3 offset:2584
	v_mfma_f32_16x16x32_bf16 v[116:119], v[160:163], v[224:227], v[116:119]
	ds_read_b64_tr_b16 v[136:137], v3 offset:32
	v_mfma_f32_16x16x32_bf16 v[52:55], v[160:163], v[228:231], v[52:55]
	ds_read_b64_tr_b16 v[138:139], v3 offset:2592
	s_waitcnt vmcnt(0) lgkmcnt(8)
	s_movk_i32 s71, 16
L_oc16:
	v_max3_u32 v96, v232, v234, v236
	v_max_u32 v96, v96, v238
	v_cmp_eq_u32 vcc, -1, v96
	s_cbranch_vccnz L_retry
L_od16:
	v_mfma_f32_16x16x32_bf16 v[36:39], v[120:123], v[236:239], v[36:39]
	s_waitcnt lgkmcnt(6)
	v_mfma_f32_16x16x32_bf16 v[40:43], v[124:127], v[236:239], v[40:43]
	s_waitcnt lgkmcnt(4)
	v_mfma_f32_16x16x32_bf16 v[44:47], v[128:131], v[236:239], v[44:47]
	s_waitcnt lgkmcnt(2)
	v_mfma_f32_16x16x32_bf16 v[48:51], v[132:135], v[236:239], v[48:51]
	s_waitcnt lgkmcnt(0)
	v_mfma_f32_16x16x32_bf16 v[52:55], v[136:139], v[236:239], v[52:55]
	v_mfma_f32_16x16x32_bf16 v[100:103], v[120:123], v[232:235], v[100:103]
	ds_write_b128 v88, v[36:39] offset:5120
	v_mfma_f32_16x16x32_bf16 v[104:107], v[124:127], v[232:235], v[104:107]
	ds_write_b128 v88, v[40:43] offset:6144
	v_mfma_f32_16x16x32_bf16 v[108:111], v[128:131], v[232:235], v[108:111]
	ds_write_b128 v88, v[44:47] offset:7168
	v_mfma_f32_16x16x32_bf16 v[112:115], v[132:135], v[232:235], v[112:115]
	ds_write_b128 v88, v[48:51] offset:8192
	v_mfma_f32_16x16x32_bf16 v[116:119], v[136:139], v[232:235], v[116:119]
	ds_write_b128 v88, v[52:55] offset:9216
	s_cmp_ge_u32 s19, 2
	s_cbranch_scc1 L_rB
	s_nop 2
	ds_write_b128 v88, v[112:115] offset:3072
	s_nop 0
	ds_write_b128 v88, v[116:119] offset:4096
	s_waitcnt lgkmcnt(0)
	s_barrier
	ds_read_b128 v[56:59], v89 offset:0
	ds_read_b128 v[60:63], v89 offset:1024
	ds_read_b128 v[64:67], v89 offset:2048
	ds_read_b128 v[68:71], v90 offset:0
	ds_read_b128 v[72:75], v90 offset:1024
	ds_read_b128 v[76:79], v90 offset:2048
	ds_read_b128 v[16:19], v91 offset:0
	ds_read_b128 v[20:23], v91 offset:1024
	ds_read_b128 v[24:27], v91 offset:2048
	s_waitcnt lgkmcnt(6)
	v_pk_add_f32 v[100:101], v[100:101], v[56:57]
	v_pk_add_f32 v[102:103], v[102:103], v[58:59]
	v_pk_add_f32 v[104:105], v[104:105], v[60:61]
	v_pk_add_f32 v[106:107], v[106:107], v[62:63]
	v_pk_add_f32 v[108:109], v[108:109], v[64:65]
	v_pk_add_f32 v[110:111], v[110:111], v[66:67]
	s_waitcnt lgkmcnt(3)
	v_pk_add_f32 v[100:101], v[100:101], v[68:69]
	v_pk_add_f32 v[102:103], v[102:103], v[70:71]
	v_pk_add_f32 v[104:105], v[104:105], v[72:73]
	v_pk_add_f32 v[106:107], v[106:107], v[74:75]
	v_pk_add_f32 v[108:109], v[108:109], v[76:77]
	v_pk_add_f32 v[110:111], v[110:111], v[78:79]
	s_waitcnt lgkmcnt(0)
	v_pk_add_f32 v[100:101], v[100:101], v[16:17]
	v_pk_add_f32 v[102:103], v[102:103], v[18:19]
	v_pk_add_f32 v[104:105], v[104:105], v[20:21]
	v_pk_add_f32 v[106:107], v[106:107], v[22:23]
	v_pk_add_f32 v[108:109], v[108:109], v[24:25]
	v_pk_add_f32 v[110:111], v[110:111], v[26:27]
	v_cvt_pk_bf16_f32 v56, v100, v101
	v_cvt_pk_bf16_f32 v57, v102, v103
	v_cvt_pk_bf16_f32 v58, v104, v105
	v_cvt_pk_bf16_f32 v59, v106, v107
	v_cvt_pk_bf16_f32 v60, v108, v109
	v_cvt_pk_bf16_f32 v61, v110, v111
	buffer_store_dwordx4 v[56:59], v92, s[4:7], s63 offen
	buffer_store_dwordx2 v[60:61], v92, s[4:7], s63 offen offset:16
	s_endpgm
L_rB:
	ds_write_b128 v88, v[100:103] offset:0
	ds_write_b128 v88, v[104:107] offset:1024
	ds_write_b128 v88, v[108:111] offset:2048
	s_waitcnt lgkmcnt(0)
	s_barrier
	ds_read_b128 v[56:59], v89 offset:3072
	ds_read_b128 v[60:63], v89 offset:4096
	ds_read_b128 v[68:71], v90 offset:3072
	ds_read_b128 v[72:75], v90 offset:4096
	ds_read_b128 v[16:19], v91 offset:3072
	ds_read_b128 v[20:23], v91 offset:4096
	s_waitcnt lgkmcnt(4)
	v_pk_add_f32 v[112:113], v[112:113], v[56:57]
	v_pk_add_f32 v[114:115], v[114:115], v[58:59]
	v_pk_add_f32 v[116:117], v[116:117], v[60:61]
	v_pk_add_f32 v[118:119], v[118:119], v[62:63]
	s_waitcnt lgkmcnt(2)
	v_pk_add_f32 v[112:113], v[112:113], v[68:69]
	v_pk_add_f32 v[114:115], v[114:115], v[70:71]
	v_pk_add_f32 v[116:117], v[116:117], v[72:73]
	v_pk_add_f32 v[118:119], v[118:119], v[74:75]
	s_waitcnt lgkmcnt(0)
	v_pk_add_f32 v[112:113], v[112:113], v[16:17]
	v_pk_add_f32 v[114:115], v[114:115], v[18:19]
	v_pk_add_f32 v[116:117], v[116:117], v[20:21]
	v_pk_add_f32 v[118:119], v[118:119], v[22:23]
	v_cvt_pk_bf16_f32 v56, v112, v113
	v_cvt_pk_bf16_f32 v57, v114, v115
	v_cvt_pk_bf16_f32 v58, v116, v117
	v_cvt_pk_bf16_f32 v59, v118, v119
	buffer_store_dwordx4 v[56:59], v92, s[4:7], s63 offen offset:24
L_done:
L_exit:
	s_endpgm
SPIN_23:
	s_mov_b32 s70, 32768
SPIN_23_l:
	s_sleep 4
	buffer_load_dword v139, v138, s[28:31], 0 offen sc1
	s_waitcnt vmcnt(0)
	v_cmp_ne_u32 s[66:67], 4, v139
	s_sub_u32 s70, s70, 1
	s_nop 0
	s_cselect_b64 s[66:67], 0, s[66:67]
	s_cmp_eq_u64 s[66:67], 0
	s_cbranch_scc0 SPIN_23_l
	s_branch RET_24
L_p0:
	s_waitcnt vmcnt(6)
	ds_read_b128 v[64:67], v41
	ds_read_b64_tr_b16 v[80:81], v40 offset:0
	ds_read_b64_tr_b16 v[82:83], v40 offset:160
	ds_read_b64_tr_b16 v[84:85], v40 offset:32
	ds_read_b64_tr_b16 v[86:87], v40 offset:192
	ds_read_b128 v[68:71], v42
	ds_read_b64_tr_b16 v[88:89], v40 offset:1280
	ds_read_b64_tr_b16 v[90:91], v40 offset:1440
	ds_read_b64_tr_b16 v[92:93], v40 offset:1312
	ds_read_b64_tr_b16 v[94:95], v40 offset:1472
	ds_read_b128 v[72:75], v43
	ds_read_b64_tr_b16 v[96:97], v40 offset:2560
	ds_read_b64_tr_b16 v[98:99], v40 offset:2720
	ds_read_b64_tr_b16 v[100:101], v40 offset:2592
	ds_read_b64_tr_b16 v[102:103], v40 offset:2752
	ds_read_b128 v[76:79], v44
	ds_read_b64_tr_b16 v[104:105], v40 offset:3840
	ds_read_b64_tr_b16 v[106:107], v40 offset:4000
	ds_read_b64_tr_b16 v[108:109], v40 offset:3872
	ds_read_b64_tr_b16 v[110:111], v40 offset:4032
	s_bitcmp1_b32 s17, 0
	s_cbranch_scc1 L_p0v
	s_waitcnt lgkmcnt(15)
	v_mfma_f32_16x16x32_bf16 v[112:115], v[80:83], v[64:67], 0
	v_mfma_f32_16x16x32_bf16 v[116:119], v[84:87], v[64:67], 0
	s_waitcnt lgkmcnt(10)
	v_mfma_f32_16x16x32_bf16 v[112:115], v[88:91], v[68:71], v[112:115]
	v_mfma_f32_16x16x32_bf16 v[116:119], v[92:95], v[68:71], v[116:119]
	s_waitcnt lgkmcnt(5)
	v_mfma_f32_16x16x32_bf16 v[112:115], v[96:99], v[72:75], v[112:115]
	v_mfma_f32_16x16x32_bf16 v[116:119], v[100:103], v[72:75], v[116:119]
	s_waitcnt lgkmcnt(0)
	v_mfma_f32_16x16x32_bf16 v[112:115], v[104:107], v[76:79], v[112:115]
	v_mfma_f32_16x16x32_bf16 v[116:119], v[108:111], v[76:79], v[116:119]
	s_branch L_p0w
L_p0v:
	s_waitcnt lgkmcnt(15)
	v_mfma_f32_16x16x32_bf16 v[112:115], v[64:67], v[80:83], 0
	v_mfma_f32_16x16x32_bf16 v[116:119], v[64:67], v[84:87], 0
	s_waitcnt lgkmcnt(10)
	v_mfma_f32_16x16x32_bf16 v[112:115], v[68:71], v[88:91], v[112:115]
	v_mfma_f32_16x16x32_bf16 v[116:119], v[68:71], v[92:95], v[116:119]
	s_waitcnt lgkmcnt(5)
	v_mfma_f32_16x16x32_bf16 v[112:115], v[72:75], v[96:99], v[112:115]
	v_mfma_f32_16x16x32_bf16 v[116:119], v[72:75], v[100:103], v[116:119]
	s_waitcnt lgkmcnt(0)
	v_mfma_f32_16x16x32_bf16 v[112:115], v[76:79], v[104:107], v[112:115]
	v_mfma_f32_16x16x32_bf16 v[116:119], v[76:79], v[108:111], v[116:119]
L_p0w:
	s_nop 6
	ds_write_b128 v39, v[112:115]
	ds_write_b128 v39, v[116:119] offset:1024
	s_waitcnt lgkmcnt(0)
	s_branch L_p0ret
L_red:
	v_add_u32 v24, 143040, v14
	ds_read_b128 v[144:147], v24 offset:0
	ds_read_b128 v[148:151], v24 offset:1024
	ds_read_b128 v[172:175], v24 offset:4096
	ds_read_b128 v[176:179], v24 offset:5120
	ds_read_b128 v[200:203], v24 offset:8192
	ds_read_b128 v[204:207], v24 offset:9216
	ds_read_b128 v[228:231], v24 offset:12288
	ds_read_b128 v[232:235], v24 offset:13312
	ds_read_b128 v[16:19], v24 offset:16384
	ds_read_b128 v[20:23], v24 offset:17408
	s_bitcmp1_b32 s17, 0
	s_movk_i32 s66, 256
	s_cselect_b32 s66, 128, s66
	s_movk_i32 s67, 128
	s_cselect_b32 s67, 320, s67
	s_cselect_b32 s68, 0, 8
	s_movk_i32 s69, 512
	s_cselect_b32 s69, 256, s69
	s_mov_b32 s70, 0x3ea52b5c
	s_cselect_b32 s70, 1.0, s70
	s_mov_b32 s71, 0
	s_cselect_b32 s71, 131072, s71
	s_mov_b32 s32, 0xffff
	s_cselect_b32 s32, 0x000f000f, s32
	s_cselect_b32 s33, s32, 0
	s_lshl_b32 s34, s3, 3
	s_lshr_b32 s35, s17, 1
	s_add_u32 s34, s34, s35
	s_mul_i32 s34, s34, 640
	s_add_u32 s71, s71, s34
	v_lshrrev_b32 v25, 5, v11
	v_mul_u32_u24 v25, s67, v25
	v_and_b32 v26, 7, v11
	v_lshl_add_u32 v25, v26, 4, v25
	v_bfe_u32 v26, v11, 4, 1
	v_lshl_add_u32 v25, v26, 3, v25
	v_bfe_u32 v26, v11, 3, 1
	v_mad_u32_u24 v27, v26, s66, v25
	v_mad_u32_u24 v28, v26, s68, v25
	v_add_u32 v28, s69, v28
	s_lshl_b32 s34, s3, 4
	s_add_u32 s34, s34, s17
	s_lshl_b32 s34, s34, 7
	s_add_u32 s34, s34, 262144
	v_mov_b32 v56, 0
	v_mov_b32 v57, 0
	s_waitcnt lgkmcnt(0)
	v_add_f32 v144, v144, v172
	v_add_f32 v200, v200, v228
	v_add_f32 v145, v145, v173
	v_add_f32 v201, v201, v229
	v_add_f32 v146, v146, v174
	v_add_f32 v202, v202, v230
	v_add_f32 v147, v147, v175
	v_add_f32 v203, v203, v231
	v_add_f32 v148, v148, v176
	v_add_f32 v204, v204, v232
	v_add_f32 v149, v149, v177
	v_add_f32 v205, v205, v233
	v_add_f32 v150, v150, v178
	v_add_f32 v206, v206, v234
	v_add_f32 v151, v151, v179
	v_add_f32 v207, v207, v235
	v_add_f32 v144, v144, v16
	v_add_f32 v145, v145, v17
	v_add_f32 v146, v146, v18
	v_add_f32 v147, v147, v19
	v_add_f32 v148, v148, v20
	v_add_f32 v149, v149, v21
	v_add_f32 v150, v150, v22
	v_add_f32 v151, v151, v23
	v_add_f32 v144, v144, v200
	v_add_f32 v145, v145, v201
	v_add_f32 v146, v146, v202
	v_add_f32 v147, v147, v203
	v_add_f32 v148, v148, v204
	v_add_f32 v149, v149, v205
	v_add_f32 v150, v150, v206
	v_add_f32 v151, v151, v207
	v_mul_f32 v144, s70, v144
	v_mul_f32 v145, s70, v145
	v_mul_f32 v146, s70, v146
	v_mul_f32 v147, s70, v147
	v_mul_f32 v148, s70, v148
	v_mul_f32 v149, s70, v149
	v_mul_f32 v150, s70, v150
	v_mul_f32 v151, s70, v151
	v_cvt_pk_bf16_f32 v172, v144, v145
	v_cvt_pk_bf16_f32 v173, v146, v147
	v_cvt_pk_bf16_f32 v174, v148, v149
	v_cvt_pk_bf16_f32 v175, v150, v151
	buffer_store_dwordx2 v[172:173], v27, s[24:27], s71 offen sc1
	s_mov_b64 exec, s[32:33]
	buffer_store_dwordx2 v[174:175], v28, s[24:27], s71 offen sc1
	s_mov_b64 exec, 1
	buffer_store_dwordx2 v[56:57], v56, s[24:27], s34 offen sc1
	s_mov_b64 exec, -1
	s_waitcnt vmcnt(9)
	s_branch L_redret
L_q2:
	s_cmp_eq_u32 s19, 3
	s_cbranch_scc1 L_q2ret
	s_mul_i32 s66, s66, 1536
	s_add_u32 s66, s66, 152064
	v_lshrrev_b32 v56, 5, v11
	v_mul_u32_u24 v56, 5888, v56
	v_lshl_add_u32 v56, v11, 3, v56
	v_add_u32 v56, s66, v56
	s_lshl_b32 s66, s18, 8
	s_add_u32 s66, s66, 163328
	v_add_u32 v57, s66, v138
	s_nop 7
	v_cvt_pk_bf16_f32 v16, v104, v105
	v_cvt_pk_bf16_f32 v17, v106, v107
	ds_write_b64 v56, v[16:17] offset:0
	v_cvt_pk_bf16_f32 v18, v120, v121
	v_cvt_pk_bf16_f32 v19, v122, v123
	ds_write_b64 v56, v[18:19] offset:1536
	v_permlane32_swap_b32 v108, v124
	v_mul_f32 v58, 0xbfb8aa3b, v108
	v_exp_f32 v58, v58
	s_nop 0
	v_add_f32 v58, 1.0, v58
	v_rcp_f32 v58, v58
	ds_write_b32 v57, v58
	s_branch L_q2ret
SPIN_25:
	s_mov_b32 s70, 32768
SPIN_25_l:
	s_sleep 4
	buffer_load_dword v8, v7, s[24:27], s61 offen sc1
	s_waitcnt vmcnt(0)
	v_cmp_ne_u32 s[66:67], 1, v8
	s_sub_u32 s70, s70, 1
	s_nop 0
	s_cselect_b64 s[66:67], 0, s[66:67]
	s_cmp_eq_u64 s[66:67], 0
	s_cbranch_scc0 SPIN_25_l
	s_branch RET_26
L_fallback:
	s_nop 7
	v_bfe_u32 v66, v11, 3, 2
	v_mul_u32_u24 v64, 640, v66
	v_lshrrev_b32 v66, 5, v11
	v_lshl_add_u32 v64, v66, 7, v64
	v_mul_u32_u24 v65, 640, v66
	v_bfe_u32 v66, v11, 2, 1
	v_lshl_add_u32 v64, v66, 6, v64
	v_and_b32 v66, 3, v11
	v_lshl_add_u32 v64, v66, 4, v64
	v_lshl_add_u32 v65, v66, 4, v65
	v_and_b32 v66, 28, v11
	v_mov_b32 v67, 0x43120
	v_lshrrev_b32 v66, v66, v67
	v_and_b32 v66, 7, v66
	v_lshl_add_u32 v65, v66, 6, v65
	v_add_u32 v65, 131072, v65
	s_mov_b32 s68, 0
	s_mov_b32 s69, -1
	v_and_b32 v66, 31, v11
	v_cmp_eq_u32 vcc, 20, v66
	v_mov_b32 v66, 0x3f803f80
	s_nop 0
	v_cndmask_b32 v208, 0, v66, vcc
	v_cndmask_b32 v209, 0, v66, vcc
	v_cndmask_b32 v210, 0, v66, vcc
	v_cndmask_b32 v211, 0, v66, vcc
	v_cndmask_b32 v212, 0, v66, vcc
	v_cndmask_b32 v213, 0, v66, vcc
	v_cndmask_b32 v214, 0, v66, vcc
	v_cndmask_b32 v215, 0, v66, vcc
	v_mov_b32 v204, 0x3f803f80
	v_mov_b32 v205, 0x3f80
	s_mov_b64 exec, s[68:69]
	v_mov_b32 v98, 0
	v_mov_b32 v99, 0
	s_mov_b64 exec, -1
	v_mov_b32 v66, 0xff800000
	s_mov_b32 s66, 0
L_fb0:
	buffer_load_dwordx4 v[200:203], v64, s[24:27], s66 offen offset:0 sc1
	s_mov_b64 exec, 0xffffffff
	buffer_load_dwordx2 v[204:205], v64, s[24:27], s66 offen offset:512 sc1
	s_mov_b64 exec, -1
	s_waitcnt vmcnt(0)
	v_mfma_f32_32x32x16_bf16 v[48:63], v[200:203], v[94:97], 0
	v_mfma_f32_32x32x8_bf16 v[48:63], v[204:205], v[98:99], v[48:63]
	s_nop 11
	v_max3_f32 v66, v66, v48, v49
	v_max3_f32 v66, v66, v50, v51
	v_max3_f32 v66, v66, v52, v53
	v_max3_f32 v66, v66, v54, v55
	v_max3_f32 v66, v66, v56, v57
	v_max3_f32 v66, v66, v58, v59
	v_max3_f32 v66, v66, v60, v61
	v_max3_f32 v66, v66, v62, v63
	buffer_load_dwordx4 v[200:203], v64, s[24:27], s66 offen offset:256 sc1
	s_mov_b64 exec, 0xffffffff
	buffer_load_dwordx2 v[204:205], v64, s[24:27], s66 offen offset:520 sc1
	s_mov_b64 exec, -1
	s_waitcnt vmcnt(0)
	v_mfma_f32_32x32x16_bf16 v[48:63], v[200:203], v[94:97], 0
	v_mfma_f32_32x32x8_bf16 v[48:63], v[204:205], v[98:99], v[48:63]
	s_nop 11
	v_max3_f32 v66, v66, v48, v49
	v_max3_f32 v66, v66, v50, v51
	v_max3_f32 v66, v66, v52, v53
	v_max3_f32 v66, v66, v54, v55
	v_max3_f32 v66, v66, v56, v57
	v_max3_f32 v66, v66, v58, v59
	v_max3_f32 v66, v66, v60, v61
	v_max3_f32 v66, v66, v62, v63
	s_add_u32 s66, s66, 2560
	s_cmp_lt_u32 s66, 81920
	s_cbranch_scc1 L_fb0
	v_mov_b32 v67, v66
	s_nop 1
	v_permlane32_swap_b32 v66, v67
	v_max_f32 v66, v66, v67
	v_sub_f32 v66, 0, v66
	v_and_b32 v67, 0xffff0000, v66
	v_sub_f32 v66, v66, v67
	v_and_b32 v68, 0xffff0000, v66
	v_sub_f32 v66, v66, v68
	v_lshrrev_b32 v67, 16, v67
	s_mov_b64 exec, s[68:69]
	v_lshrrev_b32 v99, 16, v66
	v_or_b32 v98, v67, v68
	s_mov_b64 exec, -1
	v_mov_b32 v32, 0
	v_mov_b32 v33, 0
	v_mov_b32 v34, 0
	v_mov_b32 v35, 0
	v_mov_b32 v36, 0
	v_mov_b32 v37, 0
	v_mov_b32 v38, 0
	v_mov_b32 v39, 0
	v_mov_b32 v40, 0
	v_mov_b32 v41, 0
	v_mov_b32 v42, 0
	v_mov_b32 v43, 0
	v_mov_b32 v44, 0
	v_mov_b32 v45, 0
	v_mov_b32 v46, 0
	v_mov_b32 v47, 0
	s_mov_b32 s66, 0
L_fb1:
	buffer_load_dwordx4 v[200:203], v64, s[24:27], s66 offen offset:0 sc1
	s_mov_b64 exec, 0xffffffff
	buffer_load_dwordx2 v[204:205], v64, s[24:27], s66 offen offset:512 sc1
	s_mov_b64 exec, s[72:73]
	buffer_load_dwordx4 v[208:211], v65, s[24:27], s66 offen offset:0 sc1
	buffer_load_dwordx4 v[212:215], v65, s[24:27], s66 offen offset:1280 sc1
	s_mov_b64 exec, -1
	s_waitcnt vmcnt(0)
	v_mfma_f32_32x32x16_bf16 v[48:63], v[200:203], v[94:97], 0
	v_mfma_f32_32x32x8_bf16 v[48:63], v[204:205], v[98:99], v[48:63]
	s_nop 11
	v_exp_f32 v48, v48
	v_exp_f32 v49, v49
	v_exp_f32 v50, v50
	v_exp_f32 v51, v51
	v_exp_f32 v52, v52
	v_exp_f32 v53, v53
	v_exp_f32 v54, v54
	v_exp_f32 v55, v55
	v_exp_f32 v56, v56
	v_exp_f32 v57, v57
	v_exp_f32 v58, v58
	v_exp_f32 v59, v59
	v_exp_f32 v60, v60
	v_exp_f32 v61, v61
	v_exp_f32 v62, v62
	v_exp_f32 v63, v63
	v_smfmac_f32_32x32x32_bf16 v[32:47], v[208:211], v[48:55], v87
	s_nop 0
	v_smfmac_f32_32x32x32_bf16 v[32:47], v[212:215], v[56:63], v87
	s_nop 7
	buffer_load_dwordx4 v[200:203], v64, s[24:27], s66 offen offset:256 sc1
	s_mov_b64 exec, 0xffffffff
	buffer_load_dwordx2 v[204:205], v64, s[24:27], s66 offen offset:520 sc1
	s_mov_b64 exec, s[72:73]
	buffer_load_dwordx4 v[208:211], v65, s[24:27], s66 offen offset:320 sc1
	buffer_load_dwordx4 v[212:215], v65, s[24:27], s66 offen offset:1600 sc1
	s_mov_b64 exec, -1
	s_waitcnt vmcnt(0)
	v_mfma_f32_32x32x16_bf16 v[48:63], v[200:203], v[94:97], 0
	v_mfma_f32_32x32x8_bf16 v[48:63], v[204:205], v[98:99], v[48:63]
	s_nop 11
	v_exp_f32 v48, v48
	v_exp_f32 v49, v49
	v_exp_f32 v50, v50
	v_exp_f32 v51, v51
	v_exp_f32 v52, v52
	v_exp_f32 v53, v53
	v_exp_f32 v54, v54
	v_exp_f32 v55, v55
	v_exp_f32 v56, v56
	v_exp_f32 v57, v57
	v_exp_f32 v58, v58
	v_exp_f32 v59, v59
	v_exp_f32 v60, v60
	v_exp_f32 v61, v61
	v_exp_f32 v62, v62
	v_exp_f32 v63, v63
	v_smfmac_f32_32x32x32_bf16 v[32:47], v[208:211], v[48:55], v87
	s_nop 0
	v_smfmac_f32_32x32x32_bf16 v[32:47], v[212:215], v[56:63], v87
	s_nop 7
	s_add_u32 s66, s66, 2560
	s_cmp_lt_u32 s66, 81920
	s_cbranch_scc1 L_fb1
	s_mov_b64 s[74:75], 0
	s_nop 7
	s_nop 7
	s_branch L_fin
L_retry:
	s_waitcnt vmcnt(0)
	s_sleep 2
	v_max3_u32 v96, v200, v202, v204
	v_max_u32 v96, v96, v206
	v_cmp_eq_u32 vcc, -1, v96
	s_cbranch_vccz L_rs12
	buffer_load_dwordx4 v[200:203], v5, s[24:27], s64 offen sc1
	buffer_load_dwordx4 v[204:207], v6, s[24:27], s64 offen sc1
L_rs12:
	v_max3_u32 v96, v208, v210, v212
	v_max_u32 v96, v96, v214
	v_cmp_eq_u32 vcc, -1, v96
	s_cbranch_vccz L_rs13
	buffer_load_dwordx4 v[208:211], v5, s[24:27], s65 offen sc1
	buffer_load_dwordx4 v[212:215], v6, s[24:27], s65 offen sc1
L_rs13:
	v_max3_u32 v96, v216, v218, v220
	v_max_u32 v96, v96, v222
	v_cmp_eq_u32 vcc, -1, v96
	s_cbranch_vccz L_rs14
	buffer_load_dwordx4 v[216:219], v5, s[24:27], s66 offen sc1
	buffer_load_dwordx4 v[220:223], v6, s[24:27], s66 offen sc1
L_rs14:
	v_max3_u32 v96, v224, v226, v228
	v_max_u32 v96, v96, v230
	v_cmp_eq_u32 vcc, -1, v96
	s_cbranch_vccz L_rs15
	buffer_load_dwordx4 v[224:227], v5, s[24:27], s67 offen sc1
	buffer_load_dwordx4 v[228:231], v6, s[24:27], s67 offen sc1
L_rs15:
	v_max3_u32 v96, v232, v234, v236
	v_max_u32 v96, v96, v238
	v_cmp_eq_u32 vcc, -1, v96
	s_cbranch_vccz L_rs16
	buffer_load_dwordx2 v[232:233], v8, s[24:27], s68 offen offset:0 sc1
	buffer_load_dwordx2 v[234:235], v8, s[24:27], s68 offen offset:128 sc1
	buffer_load_dwordx2 v[236:237], v9, s[24:27], s68 offen offset:0 sc1
	buffer_load_dwordx2 v[238:239], v9, s[24:27], s68 offen offset:128 sc1
L_rs16:
	s_sub_u32 s70, s70, 1
	s_cselect_b32 s70, 0, s70
	s_cselect_b32 s69, 0x100, 0
	s_or_b32 s69, s69, s71
	s_waitcnt vmcnt(0)
	s_cmp_eq_u32 s69, 12
	s_cbranch_scc1 L_oc12
	s_cmp_eq_u32 s69, 13
	s_cbranch_scc1 L_oc13
	s_cmp_eq_u32 s69, 14
	s_cbranch_scc1 L_oc14
	s_cmp_eq_u32 s69, 15
	s_cbranch_scc1 L_oc15
	s_cmp_eq_u32 s69, 16
	s_cbranch_scc1 L_oc16
	s_cmp_eq_u32 s71, 12
	s_cbranch_scc1 L_od12
	s_cmp_eq_u32 s71, 13
	s_cbranch_scc1 L_od13
	s_cmp_eq_u32 s71, 14
	s_cbranch_scc1 L_od14
	s_cmp_eq_u32 s71, 15
	s_cbranch_scc1 L_od15
	s_cmp_eq_u32 s71, 16
	s_cbranch_scc1 L_od16
	s_endpgm
L_last:
	s_endpgm
.section .rodata,"a"
.p2align 6
.amdhsa_kernel gated_mix__grouped_kv_mqa__glu_gated_geglu__prompt_kernel
  .amdhsa_next_free_vgpr 256
  .amdhsa_next_free_sgpr 102
  .amdhsa_accum_offset 256
  .amdhsa_group_segment_fixed_size 0
  .amdhsa_kernarg_size 104
  .amdhsa_user_sgpr_count 2
  .amdhsa_user_sgpr_kernarg_segment_ptr 1
  .amdhsa_system_sgpr_workgroup_id_x 1
.end_amdhsa_kernel
```
